```python
import torch

def _softmax(x, axis=-1):
    return torch.softmax(x, dim=axis)

def _gelu(x):
    return torch.nn.functional.gelu(x, approximate='tanh')

def _silu(x):
    return torch.nn.functional.silu(x)

def _sigmoid(x):
    return torch.sigmoid(x)

def _layernorm(x, axis=-1, eps=1e-05):
    m = x.mean(dim=axis, keepdim=True)
    v = x.var(dim=axis, keepdim=True, unbiased=False)
    return (x - m) / torch.sqrt(v + eps)

def _scatter_add(tgt, idx, src, axis=0):
    return tgt.clone().index_add_(axis, idx, src)

def _segment_sum(src, seg, n):
    out = torch.zeros((n,) + src.shape[1:], dtype=src.dtype)
    return out.index_add_(0, seg, src)

def _pad(x, pw):
    flat = tuple((v for pair in reversed(pw) for v in pair))
    return torch.nn.functional.pad(x, flat)
kernel_name = 'adaLN_cond__gqa_block_cached__swiglu_ffn__decode'

def setup_inputs():

    _w = lambda a: (lambda t: t.to(torch.bfloat16) if t.is_floating_point() else t)(torch.as_tensor(a))

    def _A_setup():
        B, Sq, D = (2, 1, 640)
        Hq, Hkv, Sk, Dh = (32, 32, 8192, 192)
        assert Hq % Hkv == 0, (Hq, Hkv)
        return {'x': _w((lambda *s: torch.randn(*s, dtype=torch.bfloat16) * 0.05)(B, Sq, D)), 'k_cache': _w((lambda *s: torch.randn(*s, dtype=torch.bfloat16) * 0.8)(B, Hkv, Sk, Dh)), 'v_cache': _w((lambda *s: torch.randn(*s, dtype=torch.bfloat16) * 1.6)(B, Hkv, Sk, Dh)), 'wq': _w((lambda *s: torch.randn(*s, dtype=torch.bfloat16) * 0.8)(D, Hq * Dh) * D ** (-0.5)), 'wo': _w((lambda *s: torch.randn(*s, dtype=torch.bfloat16) * 1.6)(Hq * Dh, D) * (Hq * Dh) ** (-0.5))}
    _A_in = _A_setup()

    def _B_setup():
        B, S, D, F = (2, 1, 640, 1536)
        return {'x': _w((lambda *s: torch.randn(*s, dtype=torch.bfloat16) * 0.05)(B, S, D)), 'w_gate': _w((lambda *s: torch.randn(*s, dtype=torch.bfloat16) * 0.1)(D, F)), 'w_up': _w((lambda *s: torch.randn(*s, dtype=torch.bfloat16) * 0.1)(D, F)), 'w_down': _w((lambda *s: torch.randn(*s, dtype=torch.bfloat16) * 0.1)(F, D))}
    _B_in = _B_setup()
    return {'A_x': _A_in['x'], 'A_k_cache': _A_in['k_cache'], 'A_v_cache': _A_in['v_cache'], 'A_wq': _A_in['wq'], 'A_wo': _A_in['wo'], 'B_x': _B_in['x'], 'B_w_gate': _B_in['w_gate'], 'B_w_up': _B_in['w_up'], 'B_w_down': _B_in['w_down'], 'c': _w((lambda *s: torch.randn(*s, dtype=torch.bfloat16) * 0.4)(2, 640) * 8.0), 'w_mod': _w((lambda *s: torch.randn(*s, dtype=torch.bfloat16) * 0.4)(640, 6 * 640) * 640 ** (-0.5) * 8.0)}

def reference(A_x, A_k_cache, A_v_cache, A_wq, A_wo, B_x, B_w_gate, B_w_up, B_w_down, c, w_mod):

    def _A_ref(x, k_cache, v_cache, wq, wo):
        B, Sq, D = x.shape
        Hq, Dh = (32, 192)
        Hkv = k_cache.shape[1]
        rep = Hq // Hkv
        q = (lambda x, *d: x.permute(*d))((x @ wq).reshape(B, Sq, Hq, Dh), 0, 2, 1, 3)
        k = (lambda x, n, axis: torch.repeat_interleave(x, n, dim=axis))(k_cache, rep, axis=1)
        v = (lambda x, n, axis: torch.repeat_interleave(x, n, dim=axis))(v_cache, rep, axis=1)
        scores = torch.einsum('bhqd,bhkd->bhqk', q, k) * Dh ** (-0.5)
        p = _softmax(scores, axis=-1)
        o = torch.einsum('bhqk,bhkd->bhqd', p, v)
        return (lambda x, *d: x.permute(*d))(o, 0, 2, 1, 3).reshape(B, Sq, Hq * Dh) @ wo

    def _B_ref(x, w_gate, w_up, w_down):
        g = _silu(x @ w_gate)
        u = x @ w_up
        return g * u @ w_down
    x = A_x
    mod = (_silu(c) @ w_mod).reshape(c.shape[0], 6, 1, -1)
    sa, ca, ga, sb, cb, gb = (mod[:, 0].clone(), mod[:, 1].clone(), mod[:, 2].clone(), mod[:, 3].clone(), mod[:, 4].clone(), mod[:, 5].clone())
    h = _layernorm(x, axis=-1) * (1 + ca) + sa
    x = x + ga * _A_ref(h, A_k_cache, A_v_cache, A_wq, A_wo)
    h = _layernorm(x, axis=-1) * (1 + cb) + sb
    x = x + gb * _B_ref(h, B_w_gate, B_w_up, B_w_down)
    return x
```

```asm
; @launch grid=(256,1,1) block=(768,1,1) lds=158720
.amdgcn_target "amdgcn-amd-amdhsa--gfx950"
.text
.globl adaLN_cond__gqa_block_cached__swiglu_ffn__decode_kernel
.p2align 8
.type adaLN_cond__gqa_block_cached__swiglu_ffn__decode_kernel,@function
adaLN_cond__gqa_block_cached__swiglu_ffn__decode_kernel:
    s_cmp_ge_u32 s2, 256
    s_cbranch_scc1 L_end
    s_load_dwordx16 s[16:31], s[0:1], 0
    s_load_dwordx8 s[32:39], s[0:1], 64
    s_load_dwordx4 s[40:43], s[0:1], 96
    v_readfirstlane_b32 s3, v0
    v_and_b32 v0, 63, v0
    s_and_b32 s48, s2, 7
    s_lshr_b32 s4, s2, 6
    s_bfe_u32 s46, s2, 0x30003
    s_lshl2_add_u32 s45, s48, s4
    s_lshr_b32 s3, s3, 6
    s_cmp_ge_u32 s3, 8
    s_cbranch_scc1 L_service
    v_bfe_u32 v1, v0, 1, 3
    v_mul_u32_u24 v1, 384, v1
    v_lshrrev_b32 v2, 4, v0
    v_lshl_add_u32 v1, v2, 5, v1
    v_and_b32 v2, 1, v0
    v_lshl_add_u32 v1, v2, 4, v1
    s_bfe_u32 s7, s2, 0x40003
    s_lshl3_add_u32 s7, s7, s3
    s_mul_i32 s4, s7, 3072
    s_lshr_b32 s10, s2, 7
    s_lshl3_add_u32 s10, s10, s48
    s_mul_i32 s5, s10, 3145728
    s_add_u32 s4, s4, s5
    s_add_u32 s4, s4, 100663296
    s_add_u32 s6, s4, 3145728
    s_mul_i32 s5, s10, 6
    s_and_b32 s5, s5, 7
    s_mul_i32 s5, s5, 393216
    s_add_u32 s5, s5, s4
    s_mov_b32 s58, 201326592
    s_mov_b32 s59, 0x20000
    s_waitcnt lgkmcnt(0)
    s_mov_b64 s[56:57], s[18:19]
    buffer_load_dwordx4 v[24:27], v1, s[56:59], s5 offen offset:0 nt
    buffer_load_dwordx4 v[28:31], v1, s[56:59], s5 offen offset:128 nt
    buffer_load_dwordx4 v[32:35], v1, s[56:59], s5 offen offset:256 nt
    s_add_u32 s5, s5, 393216
    s_cmp_ge_u32 s5, s6
    s_cselect_b32 s5, s4, s5
    s_lshr_b32 s49, s2, 3
    s_lshr_b32 s11, s2, 6
    s_mov_b32 s14, 0
    s_mov_b32 s12, s3
    s_cmp_lt_u32 s46, 5
    s_cbranch_scc0 L_nonB_1
    s_and_b32 s9, s11, 1
    s_mul_i32 s51, s9, 5
    s_add_u32 s51, s51, s46
    s_and_b32 s9, s11, 2
    s_lshl2_add_u32 s51, s51, s9
    s_and_b32 s9, s3, 1
    s_add_u32 s51, s51, s9
    s_mov_b32 s15, 1
    s_branch L_roles_2
L_nonB_1:
    s_mul_i32 s8, s11, 3
    s_add_u32 s8, s8, s46
    s_sub_u32 s8, s8, 5
    s_mul_i32 s51, s48, 6
    s_add_u32 s51, s51, s8
    s_add_u32 s9, s8, 10
    s_and_b32 s9, s9, 14
    s_lshl_b32 s10, s9, 2
    s_add_u32 s10, s10, s48
    s_lshl_b32 s14, s10, 1
    s_and_b32 s9, s8, 1
    s_add_u32 s14, s14, s9
    s_cmp_lt_u32 s10, 10
    s_cselect_b32 s15, 8, 0
    s_cmp_lt_u32 s8, 6
    s_cselect_b32 s15, 2, s15
L_roles_2:
    s_waitcnt lgkmcnt(0)
    s_load_dword s44, s[42:43], 0
    s_mov_b32 s52, s42
    s_mov_b32 s53, s43
    s_mov_b32 s54, 2490368
    s_mov_b32 s55, 0x20000
    s_mov_b32 s60, s20
    s_mov_b32 s61, s21
    s_mov_b32 s62, 201326592
    s_mov_b32 s63, 0x20000
    s_barrier
    s_waitcnt vmcnt(2)
    buffer_load_dwordx4 v[36:39], v1, s[56:59], s5 offen offset:0 nt
    s_mov_b32 s8, 0xaaaaaaaa
    s_mov_b32 s9, 0xaaaaaaaa
    v_and_b32 v2, 1, v0
    v_mul_u32_u24 v2, 16, v2
    v_lshrrev_b32 v3, 4, v0
    v_mul_u32_u24 v3, 32, v3
    v_add_u32 v2, v2, v3
    s_waitcnt lgkmcnt(0)
    s_add_u32 s44, s44, 0x9e3779b1
    s_waitcnt vmcnt(2)
    buffer_load_dwordx4 v[40:43], v1, s[56:59], s5 offen offset:128 nt
    s_waitcnt vmcnt(2)
    buffer_load_dwordx4 v[44:47], v1, s[56:59], s5 offen offset:256 nt
    s_add_u32 s5, s5, 393216
    s_cmp_ge_u32 s5, s6
    s_cselect_b32 s5, s4, s5
    s_waitcnt vmcnt(2)
    buffer_load_dwordx4 v[48:51], v1, s[56:59], s5 offen offset:0 nt
    s_waitcnt vmcnt(2)
    buffer_load_dwordx4 v[52:55], v1, s[56:59], s5 offen offset:128 nt
    s_waitcnt vmcnt(2)
    buffer_load_dwordx4 v[56:59], v1, s[56:59], s5 offen offset:256 nt
    s_add_u32 s5, s5, 393216
    s_cmp_ge_u32 s5, s6
    s_cselect_b32 s5, s4, s5
    s_waitcnt vmcnt(2)
    buffer_load_dwordx4 v[60:63], v1, s[56:59], s5 offen offset:0 nt
    s_waitcnt vmcnt(2)
    buffer_load_dwordx4 v[64:67], v1, s[56:59], s5 offen offset:128 nt
    s_waitcnt vmcnt(2)
    buffer_load_dwordx4 v[68:71], v1, s[56:59], s5 offen offset:256 nt
    s_add_u32 s5, s5, 393216
    s_cmp_ge_u32 s5, s6
    s_cselect_b32 s5, s4, s5
    s_waitcnt vmcnt(2)
    buffer_load_dwordx4 v[72:75], v1, s[56:59], s5 offen offset:0 nt
    s_waitcnt vmcnt(2)
    buffer_load_dwordx4 v[76:79], v1, s[56:59], s5 offen offset:128 nt
    s_waitcnt vmcnt(2)
    buffer_load_dwordx4 v[80:83], v1, s[56:59], s5 offen offset:256 nt
    s_add_u32 s5, s5, 393216
    s_cmp_ge_u32 s5, s6
    s_cselect_b32 s5, s4, s5
    s_waitcnt vmcnt(2)
    buffer_load_dwordx4 v[84:87], v1, s[56:59], s5 offen offset:0 nt
    s_waitcnt vmcnt(2)
    buffer_load_dwordx4 v[88:91], v1, s[56:59], s5 offen offset:128 nt
    s_waitcnt vmcnt(2)
    buffer_load_dwordx4 v[92:95], v1, s[56:59], s5 offen offset:256 nt
    s_add_u32 s5, s5, 393216
    s_cmp_ge_u32 s5, s6
    s_cselect_b32 s5, s4, s5
    s_waitcnt vmcnt(2)
    buffer_load_dwordx4 v[96:99], v1, s[56:59], s5 offen offset:0 nt
    s_waitcnt vmcnt(2)
    buffer_load_dwordx4 v[100:103], v1, s[56:59], s5 offen offset:128 nt
    s_waitcnt vmcnt(2)
    buffer_load_dwordx4 v[104:107], v1, s[56:59], s5 offen offset:256 nt
    s_add_u32 s5, s5, 393216
    s_cmp_ge_u32 s5, s6
    s_cselect_b32 s5, s4, s5
    s_waitcnt vmcnt(2)
    buffer_load_dwordx4 v[108:111], v1, s[56:59], s5 offen offset:0 nt
    s_waitcnt vmcnt(2)
    buffer_load_dwordx4 v[112:115], v1, s[56:59], s5 offen offset:128 nt
    s_waitcnt vmcnt(2)
    buffer_load_dwordx4 v[116:119], v1, s[56:59], s5 offen offset:256 nt
    s_add_u32 s5, s5, 393216
    s_cmp_ge_u32 s5, s6
    s_cselect_b32 s5, s4, s5
    s_add_u32 s4, s4, 50331648
    s_add_u32 s5, s5, 50331648
    s_add_u32 s6, s6, 50331648
    s_waitcnt vmcnt(2)
    buffer_load_dwordx4 v[120:123], v1, s[56:59], s5 offen offset:0 nt
    s_waitcnt vmcnt(2)
    buffer_load_dwordx4 v[124:127], v1, s[56:59], s5 offen offset:128 nt
    s_waitcnt vmcnt(2)
    buffer_load_dwordx4 v[128:131], v1, s[56:59], s5 offen offset:256 nt
    s_add_u32 s5, s5, 393216
    s_cmp_ge_u32 s5, s6
    s_cselect_b32 s5, s4, s5
    s_waitcnt vmcnt(2)
    buffer_load_dwordx4 v[132:135], v1, s[56:59], s5 offen offset:0 nt
    s_waitcnt vmcnt(2)
    buffer_load_dwordx4 v[136:139], v1, s[56:59], s5 offen offset:128 nt
    s_waitcnt vmcnt(2)
    buffer_load_dwordx4 v[140:143], v1, s[56:59], s5 offen offset:256 nt
    s_add_u32 s5, s5, 393216
    s_cmp_ge_u32 s5, s6
    s_cselect_b32 s5, s4, s5
    s_waitcnt vmcnt(2)
    buffer_load_dwordx4 v[144:147], v1, s[56:59], s5 offen offset:0 nt
    s_waitcnt vmcnt(2)
    buffer_load_dwordx4 v[148:151], v1, s[56:59], s5 offen offset:128 nt
    s_waitcnt vmcnt(2)
    buffer_load_dwordx4 v[152:155], v1, s[56:59], s5 offen offset:256 nt
    s_add_u32 s5, s5, 393216
    s_cmp_ge_u32 s5, s6
    s_cselect_b32 s5, s4, s5
    s_waitcnt vmcnt(2)
    buffer_load_dwordx4 v[156:159], v1, s[56:59], s5 offen offset:0 nt
    s_waitcnt vmcnt(2)
    buffer_load_dwordx4 v[160:163], v1, s[56:59], s5 offen offset:128 nt
    s_waitcnt vmcnt(2)
    buffer_load_dwordx4 v[164:167], v1, s[56:59], s5 offen offset:256 nt
    s_add_u32 s5, s5, 393216
    s_cmp_ge_u32 s5, s6
    s_cselect_b32 s5, s4, s5
    s_barrier
    ds_read_b128 v[4:7], v2 offset:768
    ds_read_b128 v[8:11], v2 offset:896
    ds_read_b128 v[12:15], v2 offset:1024
    v_mov_b32 v3, 1536
    ds_read_b32 v3, v3
    s_waitcnt lgkmcnt(0)
    v_readfirstlane_b32 s50, v3
    s_nop 0
    s_sub_u32 s50, s50, 1
    v_mfma_f32_16x16x32_bf16 v[16:19], v[4:7], v[24:27], 0
    v_mfma_f32_16x16x32_bf16 v[16:19], v[8:11], v[28:31], v[16:19]
    v_mfma_f32_16x16x32_bf16 v[16:19], v[12:15], v[32:35], v[16:19]
    v_mfma_f32_16x16x32_bf16 v[20:23], v[4:7], v[36:39], 0
    v_mfma_f32_16x16x32_bf16 v[20:23], v[8:11], v[40:43], v[20:23]
    v_mfma_f32_16x16x32_bf16 v[20:23], v[12:15], v[44:47], v[20:23]
    s_nop 4
    v_cndmask_b32_e64 v2, v16, v17, s[8:9]
    s_nop 1
    v_add_f32_dpp v24, v2, v2 quad_perm:[1,0,3,2] row_mask:1 bank_mask:0xf
    v_lshrrev_b32 v41, 3, v0
    v_mul_u32_u24 v40, 384, v41
    v_lshlrev_b32 v41, 3, v41
    v_and_b32 v43, 7, v0
    v_lshl_add_u32 v40, v43, 4, v40
    v_and_b32 v42, 1, v0
    v_lshlrev_b32 v42, 4, v42
    v_mov_b32 v36, 0xffff
    v_lshlrev_b32 v42, v42, v36
    v_lshrrev_b32 v43, 1, v43
    v_cmp_eq_u32 vcc, 0, v43
    s_nop 1
    v_cndmask_b32 v36, 0, v42, vcc
    v_cmp_eq_u32 vcc, 1, v43
    s_nop 1
    v_cndmask_b32 v37, 0, v42, vcc
    v_cmp_eq_u32 vcc, 2, v43
    s_nop 1
    v_cndmask_b32 v38, 0, v42, vcc
    v_cmp_eq_u32 vcc, 3, v43
    s_nop 1
    v_cndmask_b32 v39, 0, v42, vcc
    v_and_b32 v43, 1, v0
    v_mul_u32_u24 v43, 16, v43
    v_lshrrev_b32 v42, 4, v0
    v_mul_u32_u24 v42, 32, v42
    v_add_u32 v43, v43, v42
    v_mfma_f32_16x16x32_bf16 v[16:19], v[4:7], v[48:51], 0
    s_cmp_eq_u32 s3, 3
    s_cselect_b32 s10, 0, 4
    v_mov_b32 v49, s10
    v_mov_b32 v50, 0
    v_mfma_f32_16x16x32_bf16 v[16:19], v[8:11], v[52:55], v[16:19]
    s_waitcnt vmcnt(2)
    buffer_load_dwordx4 v[52:55], v1, s[56:59], s5 offen offset:0 nt
    v_mfma_f32_16x16x32_bf16 v[16:19], v[12:15], v[56:59], v[16:19]
    v_cndmask_b32_e64 v2, v20, v21, s[8:9]
    s_nop 1
    v_add_f32_dpp v24, v2, v2 quad_perm:[1,0,3,2] row_mask:2 bank_mask:0xf
    v_mfma_f32_16x16x32_bf16 v[20:23], v[4:7], v[60:63], 0
    v_mfma_f32_16x16x32_bf16 v[20:23], v[8:11], v[64:67], v[20:23]
    s_waitcnt vmcnt(2)
    buffer_load_dwordx4 v[56:59], v1, s[56:59], s5 offen offset:128 nt
    v_mfma_f32_16x16x32_bf16 v[20:23], v[12:15], v[68:71], v[20:23]
    v_cndmask_b32_e64 v2, v16, v17, s[8:9]
    s_nop 1
    v_add_f32_dpp v24, v2, v2 quad_perm:[1,0,3,2] row_mask:4 bank_mask:0xf
    v_mfma_f32_16x16x32_bf16 v[16:19], v[4:7], v[72:75], 0
    v_mfma_f32_16x16x32_bf16 v[16:19], v[8:11], v[76:79], v[16:19]
    s_waitcnt vmcnt(2)
    buffer_load_dwordx4 v[60:63], v1, s[56:59], s5 offen offset:256 nt
    s_add_u32 s5, s5, 393216
    s_cmp_ge_u32 s5, s6
    s_cselect_b32 s5, s4, s5
    v_mfma_f32_16x16x32_bf16 v[16:19], v[12:15], v[80:83], v[16:19]
    v_cndmask_b32_e64 v2, v20, v21, s[8:9]
    s_nop 1
    v_add_f32_dpp v24, v2, v2 quad_perm:[1,0,3,2] row_mask:8 bank_mask:0xf
    v_cvt_pk_bf16_f32 v24, v24, v24
    v_and_b32 v24, 0xffff0000, v24
    v_mul_f32 v24, 0x3d93cd3a, v24
    v_cvt_pk_bf16_f32 v24, v24, v24
    v_and_b32 v24, 0xffff0000, v24
    v_mfma_f32_16x16x32_bf16 v[20:23], v[4:7], v[84:87], 0
    v_mfma_f32_16x16x32_bf16 v[20:23], v[8:11], v[88:91], v[20:23]
    s_waitcnt vmcnt(2)
    buffer_load_dwordx4 v[64:67], v1, s[56:59], s5 offen offset:0 nt
    v_mov_b32 v48, 40
    ds_write_b32 v49, v48 offset:1544
    ds_read_b32 v48, v50 offset:1552
    v_mfma_f32_16x16x32_bf16 v[20:23], v[12:15], v[92:95], v[20:23]
    v_cndmask_b32_e64 v2, v16, v17, s[8:9]
    s_nop 1
    v_add_f32_dpp v25, v2, v2 quad_perm:[1,0,3,2] row_mask:1 bank_mask:0xf
    v_mfma_f32_16x16x32_bf16 v[16:19], v[4:7], v[96:99], 0
    v_mfma_f32_16x16x32_bf16 v[16:19], v[8:11], v[100:103], v[16:19]
    s_waitcnt vmcnt(2)
    buffer_load_dwordx4 v[68:71], v1, s[56:59], s5 offen offset:128 nt
    v_mov_b32 v48, 41
    ds_write_b32 v49, v48 offset:1544
    ds_read_b32 v48, v50 offset:1552
    v_mfma_f32_16x16x32_bf16 v[16:19], v[12:15], v[104:107], v[16:19]
    v_cndmask_b32_e64 v2, v20, v21, s[8:9]
    s_nop 1
    v_add_f32_dpp v25, v2, v2 quad_perm:[1,0,3,2] row_mask:2 bank_mask:0xf
    v_mfma_f32_16x16x32_bf16 v[20:23], v[4:7], v[108:111], 0
    v_mfma_f32_16x16x32_bf16 v[20:23], v[8:11], v[112:115], v[20:23]
    s_waitcnt vmcnt(2)
    buffer_load_dwordx4 v[72:75], v1, s[56:59], s5 offen offset:256 nt
    s_add_u32 s5, s5, 393216
    s_cmp_ge_u32 s5, s6
    s_cselect_b32 s5, s4, s5
    v_mov_b32 v48, 42
    ds_write_b32 v49, v48 offset:1544
    ds_read_b32 v48, v50 offset:1552
    v_mfma_f32_16x16x32_bf16 v[20:23], v[12:15], v[116:119], v[20:23]
    v_cndmask_b32_e64 v2, v16, v17, s[8:9]
    s_nop 1
    v_add_f32_dpp v25, v2, v2 quad_perm:[1,0,3,2] row_mask:4 bank_mask:0xf
    ds_read_b128 v[4:7], v43 offset:1152
    ds_read_b128 v[8:11], v43 offset:1280
    ds_read_b128 v[12:15], v43 offset:1408
    s_waitcnt lgkmcnt(0)
    v_mfma_f32_16x16x32_bf16 v[16:19], v[4:7], v[120:123], 0
    v_mfma_f32_16x16x32_bf16 v[16:19], v[8:11], v[124:127], v[16:19]
    s_waitcnt vmcnt(2)
    buffer_load_dwordx4 v[76:79], v1, s[56:59], s5 offen offset:0 nt
    s_waitcnt lgkmcnt(0)
    v_cmp_gt_u32 vcc, 43, v48
    v_mov_b32 v48, 43
    ds_write_b32 v49, v48 offset:1544
    ds_read_b32 v48, v50 offset:1552
    v_mfma_f32_16x16x32_bf16 v[16:19], v[12:15], v[128:131], v[16:19]
    v_cndmask_b32_e64 v2, v20, v21, s[8:9]
    s_nop 1
    v_add_f32_dpp v25, v2, v2 quad_perm:[1,0,3,2] row_mask:8 bank_mask:0xf
    v_cvt_pk_bf16_f32 v25, v25, v25
    v_and_b32 v25, 0xffff0000, v25
    v_mul_f32 v25, 0x3d93cd3a, v25
    v_cvt_pk_bf16_f32 v25, v25, v25
    v_and_b32 v25, 0xffff0000, v25
    v_max_f32 v3, v24, v25
    s_nop 1
    v_max_f32_dpp v3, v3, v3 quad_perm:[2,3,0,1] row_mask:0xf bank_mask:0xf
    s_nop 1
    v_max_f32_dpp v3, v3, v3 row_half_mirror row_mask:0xf bank_mask:0xf
    s_nop 1
    v_max_f32_dpp v3, v3, v3 row_mirror row_mask:0xf bank_mask:0xf
    v_mov_b32 v32, v3
    s_nop 1
    v_permlane16_swap_b32 v3, v32
    v_max_f32 v3, v3, v32
    v_mov_b32 v32, v3
    s_nop 1
    v_permlane32_swap_b32 v3, v32
    v_max_f32 v3, v3, v32
    s_mov_b32 s10, 0x3fb8aa3b
    v_mul_f32 v32, s10, v3
    v_fma_f32 v24, v24, s10, -v32
    v_fma_f32 v25, v25, s10, -v32
    v_exp_f32 v24, v24
    v_exp_f32 v25, v25
    v_mov_b32_dpp v44, v3 quad_perm:[0,1,2,3] row_mask:4 bank_mask:0xf
    v_add_f32 v34, v24, v25
    v_cvt_pk_bf16_f32 v24, v24, v24
    v_cvt_pk_bf16_f32 v25, v25, v25
    v_add_f32_dpp v34, v34, v34 quad_perm:[2,3,0,1] row_mask:0xf bank_mask:0xf
    s_nop 1
    v_add_f32_dpp v34, v34, v34 row_half_mirror row_mask:0xf bank_mask:0xf
    s_nop 1
    v_add_f32_dpp v34, v34, v34 row_mirror row_mask:0xf bank_mask:0xf
    v_mov_b32 v32, v34
    s_nop 1
    v_permlane16_swap_b32 v34, v32
    v_add_f32 v34, v34, v32
    v_mov_b32 v32, v34
    s_nop 1
    v_permlane32_swap_b32 v34, v32
    v_add_f32 v34, v34, v32
    s_nop 1
    v_mov_b32_dpp v45, v34 quad_perm:[0,1,2,3] row_mask:4 bank_mask:0xf
    v_mfma_f32_16x16x32_bf16 v[20:23], v[4:7], v[132:135], 0
    v_mfma_f32_16x16x32_bf16 v[20:23], v[8:11], v[136:139], v[20:23]
    s_waitcnt vmcnt(2)
    buffer_load_dwordx4 v[80:83], v1, s[56:59], s5 offen offset:128 nt
    s_waitcnt lgkmcnt(0)
    v_cmp_gt_u32 vcc, 44, v48
    v_mov_b32 v48, 44
    ds_write_b32 v49, v48 offset:1544
    ds_read_b32 v48, v50 offset:1552
    v_mfma_f32_16x16x32_bf16 v[20:23], v[12:15], v[140:143], v[20:23]
    v_cndmask_b32_e64 v2, v16, v17, s[8:9]
    s_nop 1
    v_add_f32_dpp v26, v2, v2 quad_perm:[1,0,3,2] row_mask:1 bank_mask:0xf
    v_mfma_f32_16x16x32_bf16 v[16:19], v[4:7], v[144:147], 0
    v_mfma_f32_16x16x32_bf16 v[16:19], v[8:11], v[148:151], v[16:19]
    s_waitcnt vmcnt(2)
    buffer_load_dwordx4 v[84:87], v1, s[56:59], s5 offen offset:256 nt
    s_add_u32 s5, s5, 393216
    s_cmp_ge_u32 s5, s6
    s_cselect_b32 s5, s4, s5
    s_waitcnt lgkmcnt(0)
    v_cmp_gt_u32 vcc, 45, v48
    v_mov_b32 v48, 45
    ds_write_b32 v49, v48 offset:1544
    ds_read_b32 v48, v50 offset:1552
    v_mfma_f32_16x16x32_bf16 v[16:19], v[12:15], v[152:155], v[16:19]
    v_cndmask_b32_e64 v2, v20, v21, s[8:9]
    s_nop 1
    v_add_f32_dpp v26, v2, v2 quad_perm:[1,0,3,2] row_mask:2 bank_mask:0xf
    v_mfma_f32_16x16x32_bf16 v[20:23], v[4:7], v[156:159], 0
    v_mfma_f32_16x16x32_bf16 v[20:23], v[8:11], v[160:163], v[20:23]
    s_waitcnt vmcnt(2)
    s_cbranch_vccz L_th_5
    s_waitcnt vmcnt(1)
L_th_5:
    buffer_load_dwordx4 v[88:91], v1, s[56:59], s5 offen offset:0 nt
    s_waitcnt lgkmcnt(0)
    v_cmp_gt_u32 vcc, 46, v48
    v_mov_b32 v48, 46
    ds_write_b32 v49, v48 offset:1544
    ds_read_b32 v48, v50 offset:1552
    v_mfma_f32_16x16x32_bf16 v[20:23], v[12:15], v[164:167], v[20:23]
    v_cndmask_b32_e64 v2, v16, v17, s[8:9]
    s_nop 1
    v_add_f32_dpp v26, v2, v2 quad_perm:[1,0,3,2] row_mask:4 bank_mask:0xf
    v_mfma_f32_16x16x32_bf16 v[16:19], v[4:7], v[52:55], 0
    v_mfma_f32_16x16x32_bf16 v[16:19], v[8:11], v[56:59], v[16:19]
    s_waitcnt vmcnt(2)
    s_cbranch_vccz L_th_6
    s_waitcnt vmcnt(1)
L_th_6:
    buffer_load_dwordx4 v[92:95], v1, s[56:59], s5 offen offset:128 nt
    s_waitcnt lgkmcnt(0)
    v_cmp_gt_u32 vcc, 47, v48
    v_mov_b32 v48, 47
    ds_write_b32 v49, v48 offset:1544
    ds_read_b32 v48, v50 offset:1552
    v_mfma_f32_16x16x32_bf16 v[16:19], v[12:15], v[60:63], v[16:19]
    v_cndmask_b32_e64 v2, v20, v21, s[8:9]
    s_nop 1
    v_add_f32_dpp v26, v2, v2 quad_perm:[1,0,3,2] row_mask:8 bank_mask:0xf
    v_cvt_pk_bf16_f32 v26, v26, v26
    v_and_b32 v26, 0xffff0000, v26
    v_mul_f32 v26, 0x3d93cd3a, v26
    v_cvt_pk_bf16_f32 v26, v26, v26
    v_and_b32 v26, 0xffff0000, v26
    v_mfma_f32_16x16x32_bf16 v[20:23], v[4:7], v[64:67], 0
    v_mfma_f32_16x16x32_bf16 v[20:23], v[8:11], v[68:71], v[20:23]
    s_waitcnt vmcnt(2)
    s_cbranch_vccz L_th_7
    s_waitcnt vmcnt(1)
L_th_7:
    buffer_load_dwordx4 v[96:99], v1, s[56:59], s5 offen offset:256 nt
    s_add_u32 s5, s5, 393216
    s_cmp_ge_u32 s5, s6
    s_cselect_b32 s5, s4, s5
    s_sub_u32 s4, s4, 150994944
    s_sub_u32 s5, s5, 150994944
    s_sub_u32 s6, s6, 150994944
    s_waitcnt lgkmcnt(0)
    v_cmp_gt_u32 vcc, 48, v48
    v_mov_b32 v48, 48
    ds_write_b32 v49, v48 offset:1544
    ds_read_b32 v48, v50 offset:1552
    v_mfma_f32_16x16x32_bf16 v[20:23], v[12:15], v[72:75], v[20:23]
    v_cndmask_b32_e64 v2, v16, v17, s[8:9]
    s_nop 1
    v_add_f32_dpp v27, v2, v2 quad_perm:[1,0,3,2] row_mask:1 bank_mask:0xf
    v_mfma_f32_16x16x32_bf16 v[16:19], v[4:7], v[76:79], 0
    v_mfma_f32_16x16x32_bf16 v[16:19], v[8:11], v[80:83], v[16:19]
    s_waitcnt vmcnt(2)
    s_cbranch_vccz L_th_8
    s_waitcnt vmcnt(1)
L_th_8:
    buffer_load_dwordx4 v[100:103], v1, s[56:59], s5 offen offset:0 nt
    s_waitcnt lgkmcnt(0)
    v_cmp_gt_u32 vcc, 49, v48
    v_mov_b32 v48, 49
    ds_write_b32 v49, v48 offset:1544
    ds_read_b32 v48, v50 offset:1552
    v_mfma_f32_16x16x32_bf16 v[16:19], v[12:15], v[84:87], v[16:19]
    v_cndmask_b32_e64 v2, v20, v21, s[8:9]
    s_nop 1
    v_add_f32_dpp v27, v2, v2 quad_perm:[1,0,3,2] row_mask:2 bank_mask:0xf
    v_mfma_f32_16x16x32_bf16 v[20:23], v[4:7], v[88:91], 0
    s_waitcnt vmcnt(2)
    s_cbranch_vccz L_th_9
    s_waitcnt vmcnt(1)
L_th_9:
    buffer_load_dwordx4 v[104:107], v1, s[56:59], s5 offen offset:128 nt
    s_waitcnt lgkmcnt(0)
    v_cmp_gt_u32 vcc, 50, v48
    v_mov_b32 v48, 50
    ds_write_b32 v49, v48 offset:1544
    ds_read_b32 v48, v50 offset:1552
    v_mfma_f32_16x16x32_bf16 v[20:23], v[8:11], v[92:95], v[20:23]
    s_waitcnt vmcnt(2)
    s_cbranch_vccz L_th_10
    s_waitcnt vmcnt(1)
L_th_10:
    buffer_load_dwordx4 v[108:111], v1, s[56:59], s5 offen offset:256 nt
    s_add_u32 s5, s5, 393216
    s_cmp_ge_u32 s5, s6
    s_cselect_b32 s5, s4, s5
    s_waitcnt lgkmcnt(0)
    v_cmp_gt_u32 vcc, 51, v48
    v_mov_b32 v48, 51
    ds_write_b32 v49, v48 offset:1544
    ds_read_b32 v48, v50 offset:1552
    v_mfma_f32_16x16x32_bf16 v[20:23], v[12:15], v[96:99], v[20:23]
    v_cndmask_b32_e64 v2, v16, v17, s[8:9]
    s_nop 1
    v_add_f32_dpp v27, v2, v2 quad_perm:[1,0,3,2] row_mask:4 bank_mask:0xf
    ds_read_b128 v[4:7], v43 offset:0
    ds_read_b128 v[8:11], v43 offset:128
    ds_read_b128 v[12:15], v43 offset:256
    s_waitcnt lgkmcnt(0)
    s_waitcnt vmcnt(2)
    s_cbranch_vccz L_th_11
    s_waitcnt vmcnt(1)
L_th_11:
    buffer_load_dwordx4 v[112:115], v1, s[56:59], s5 offen offset:0 nt
    s_waitcnt lgkmcnt(0)
    v_cmp_gt_u32 vcc, 52, v48
    v_mov_b32 v48, 52
    ds_write_b32 v49, v48 offset:1544
    ds_read_b32 v48, v50 offset:1552
    v_mfma_f32_16x16x32_bf16 v[16:19], v[4:7], v[100:103], 0
    s_waitcnt vmcnt(2)
    s_cbranch_vccz L_th_12
    s_waitcnt vmcnt(1)
L_th_12:
    buffer_load_dwordx4 v[116:119], v1, s[56:59], s5 offen offset:128 nt
    s_waitcnt lgkmcnt(0)
    v_cmp_gt_u32 vcc, 53, v48
    v_mov_b32 v48, 53
    ds_write_b32 v49, v48 offset:1544
    ds_read_b32 v48, v50 offset:1552
    v_mfma_f32_16x16x32_bf16 v[16:19], v[8:11], v[104:107], v[16:19]
    s_waitcnt vmcnt(2)
    s_cbranch_vccz L_th_13
    s_waitcnt vmcnt(1)
L_th_13:
    buffer_load_dwordx4 v[120:123], v1, s[56:59], s5 offen offset:256 nt
    s_add_u32 s5, s5, 393216
    s_cmp_ge_u32 s5, s6
    s_cselect_b32 s5, s4, s5
    s_waitcnt lgkmcnt(0)
    v_cmp_gt_u32 vcc, 54, v48
    v_mov_b32 v48, 54
    ds_write_b32 v49, v48 offset:1544
    ds_read_b32 v48, v50 offset:1552
    v_mfma_f32_16x16x32_bf16 v[16:19], v[12:15], v[108:111], v[16:19]
    v_cndmask_b32_e64 v2, v20, v21, s[8:9]
    s_nop 1
    v_add_f32_dpp v27, v2, v2 quad_perm:[1,0,3,2] row_mask:8 bank_mask:0xf
    v_cvt_pk_bf16_f32 v27, v27, v27
    v_and_b32 v27, 0xffff0000, v27
    v_mul_f32 v27, 0x3d93cd3a, v27
    v_cvt_pk_bf16_f32 v27, v27, v27
    v_and_b32 v27, 0xffff0000, v27
    v_max_f32 v3, v26, v27
    s_nop 1
    v_max_f32_dpp v3, v3, v3 quad_perm:[2,3,0,1] row_mask:0xf bank_mask:0xf
    s_nop 1
    v_max_f32_dpp v3, v3, v3 row_half_mirror row_mask:0xf bank_mask:0xf
    s_nop 1
    v_max_f32_dpp v3, v3, v3 row_mirror row_mask:0xf bank_mask:0xf
    v_mov_b32 v32, v3
    s_nop 1
    v_permlane16_swap_b32 v3, v32
    v_max_f32 v3, v3, v32
    v_mov_b32 v32, v3
    s_nop 1
    v_permlane32_swap_b32 v3, v32
    v_max_f32 v3, v3, v32
    s_mov_b32 s10, 0x3fb8aa3b
    v_mul_f32 v32, s10, v3
    v_fma_f32 v26, v26, s10, -v32
    v_fma_f32 v27, v27, s10, -v32
    v_exp_f32 v26, v26
    v_exp_f32 v27, v27
    v_mov_b32_dpp v44, v3 quad_perm:[0,1,2,3] row_mask:8 bank_mask:0xf
    v_add_f32 v34, v26, v27
    v_cvt_pk_bf16_f32 v26, v26, v26
    v_cvt_pk_bf16_f32 v27, v27, v27
    v_add_f32_dpp v34, v34, v34 quad_perm:[2,3,0,1] row_mask:0xf bank_mask:0xf
    s_nop 1
    v_add_f32_dpp v34, v34, v34 row_half_mirror row_mask:0xf bank_mask:0xf
    s_nop 1
    v_add_f32_dpp v34, v34, v34 row_mirror row_mask:0xf bank_mask:0xf
    v_mov_b32 v32, v34
    s_nop 1
    v_permlane16_swap_b32 v34, v32
    v_add_f32 v34, v34, v32
    v_mov_b32 v32, v34
    s_nop 1
    v_permlane32_swap_b32 v34, v32
    v_add_f32 v34, v34, v32
    s_nop 1
    v_mov_b32_dpp v45, v34 quad_perm:[0,1,2,3] row_mask:8 bank_mask:0xf
    s_waitcnt vmcnt(2)
    s_cbranch_vccz L_th_14
    s_waitcnt vmcnt(1)
L_th_14:
    buffer_load_dwordx4 v[124:127], v1, s[56:59], s5 offen offset:0 nt
    s_waitcnt lgkmcnt(0)
    v_cmp_gt_u32 vcc, 55, v48
    v_mov_b32 v48, 55
    ds_write_b32 v49, v48 offset:1544
    ds_read_b32 v48, v50 offset:1552
    v_mfma_f32_16x16x32_bf16 v[20:23], v[4:7], v[112:115], 0
    s_waitcnt vmcnt(2)
    s_cbranch_vccz L_th_15
    s_waitcnt vmcnt(1)
L_th_15:
    buffer_load_dwordx4 v[128:131], v1, s[56:59], s5 offen offset:128 nt
    s_waitcnt lgkmcnt(0)
    v_cmp_gt_u32 vcc, 56, v48
    v_mov_b32 v48, 56
    ds_write_b32 v49, v48 offset:1544
    ds_read_b32 v48, v50 offset:1552
    v_mfma_f32_16x16x32_bf16 v[20:23], v[8:11], v[116:119], v[20:23]
    s_waitcnt vmcnt(2)
    s_cbranch_vccz L_th_16
    s_waitcnt vmcnt(1)
L_th_16:
    buffer_load_dwordx4 v[132:135], v1, s[56:59], s5 offen offset:256 nt
    s_add_u32 s5, s5, 393216
    s_cmp_ge_u32 s5, s6
    s_cselect_b32 s5, s4, s5
    s_waitcnt lgkmcnt(0)
    v_cmp_gt_u32 vcc, 57, v48
    v_mov_b32 v48, 57
    ds_write_b32 v49, v48 offset:1544
    ds_read_b32 v48, v50 offset:1552
    v_mfma_f32_16x16x32_bf16 v[20:23], v[12:15], v[120:123], v[20:23]
    v_cndmask_b32_e64 v2, v16, v17, s[8:9]
    s_nop 1
    v_add_f32_dpp v28, v2, v2 quad_perm:[1,0,3,2] row_mask:1 bank_mask:0xf
    s_waitcnt vmcnt(2)
    s_cbranch_vccz L_th_17
    s_waitcnt vmcnt(1)
L_th_17:
    buffer_load_dwordx4 v[136:139], v1, s[56:59], s5 offen offset:0 nt
    s_waitcnt lgkmcnt(0)
    v_cmp_gt_u32 vcc, 58, v48
    v_mov_b32 v48, 58
    ds_write_b32 v49, v48 offset:1544
    ds_read_b32 v48, v50 offset:1552
    v_mfma_f32_16x16x32_bf16 v[16:19], v[4:7], v[124:127], 0
    s_waitcnt vmcnt(2)
    s_cbranch_vccz L_th_18
    s_waitcnt vmcnt(1)
L_th_18:
    buffer_load_dwordx4 v[140:143], v1, s[56:59], s5 offen offset:128 nt
    s_waitcnt lgkmcnt(0)
    v_cmp_gt_u32 vcc, 59, v48
    v_mov_b32 v48, 59
    ds_write_b32 v49, v48 offset:1544
    ds_read_b32 v48, v50 offset:1552
    v_mfma_f32_16x16x32_bf16 v[16:19], v[8:11], v[128:131], v[16:19]
    s_waitcnt vmcnt(2)
    s_cbranch_vccz L_th_19
    s_waitcnt vmcnt(1)
L_th_19:
    buffer_load_dwordx4 v[144:147], v1, s[56:59], s5 offen offset:256 nt
    s_add_u32 s5, s5, 393216
    s_cmp_ge_u32 s5, s6
    s_cselect_b32 s5, s4, s5
    s_waitcnt lgkmcnt(0)
    v_cmp_gt_u32 vcc, 60, v48
    v_mov_b32 v48, 60
    ds_write_b32 v49, v48 offset:1544
    ds_read_b32 v48, v50 offset:1552
    v_mfma_f32_16x16x32_bf16 v[16:19], v[12:15], v[132:135], v[16:19]
    v_cndmask_b32_e64 v2, v20, v21, s[8:9]
    s_nop 1
    v_add_f32_dpp v28, v2, v2 quad_perm:[1,0,3,2] row_mask:2 bank_mask:0xf
    s_waitcnt vmcnt(2)
    s_cbranch_vccz L_th_20
    s_waitcnt vmcnt(1)
L_th_20:
    buffer_load_dwordx4 v[148:151], v1, s[56:59], s5 offen offset:0 nt
    s_waitcnt lgkmcnt(0)
    v_cmp_gt_u32 vcc, 61, v48
    v_mov_b32 v48, 61
    ds_write_b32 v49, v48 offset:1544
    ds_read_b32 v48, v50 offset:1552
    v_mfma_f32_16x16x32_bf16 v[20:23], v[4:7], v[136:139], 0
    s_waitcnt vmcnt(2)
    s_cbranch_vccz L_th_21
    s_waitcnt vmcnt(1)
L_th_21:
    buffer_load_dwordx4 v[152:155], v1, s[56:59], s5 offen offset:128 nt
    s_waitcnt lgkmcnt(0)
    v_cmp_gt_u32 vcc, 62, v48
    v_mov_b32 v48, 62
    ds_write_b32 v49, v48 offset:1544
    ds_read_b32 v48, v50 offset:1552
    v_mfma_f32_16x16x32_bf16 v[20:23], v[8:11], v[140:143], v[20:23]
    s_waitcnt vmcnt(2)
    s_cbranch_vccz L_th_22
    s_waitcnt vmcnt(1)
L_th_22:
    buffer_load_dwordx4 v[156:159], v1, s[56:59], s5 offen offset:256 nt
    s_add_u32 s5, s5, 393216
    s_cmp_ge_u32 s5, s6
    s_cselect_b32 s5, s4, s5
    s_waitcnt lgkmcnt(0)
    v_cmp_gt_u32 vcc, 63, v48
    v_mov_b32 v48, 63
    ds_write_b32 v49, v48 offset:1544
    ds_read_b32 v48, v50 offset:1552
    v_mfma_f32_16x16x32_bf16 v[20:23], v[12:15], v[144:147], v[20:23]
    v_cndmask_b32_e64 v2, v16, v17, s[8:9]
    s_nop 1
    v_add_f32_dpp v28, v2, v2 quad_perm:[1,0,3,2] row_mask:4 bank_mask:0xf
    s_waitcnt vmcnt(2)
    s_cbranch_vccz L_th_23
    s_waitcnt vmcnt(1)
L_th_23:
    buffer_load_dwordx4 v[160:163], v1, s[56:59], s5 offen offset:0 nt
    s_waitcnt lgkmcnt(0)
    v_cmp_gt_u32 vcc, 64, v48
    v_mov_b32 v48, 64
    ds_write_b32 v49, v48 offset:1544
    ds_read_b32 v48, v50 offset:1552
    v_mfma_f32_16x16x32_bf16 v[16:19], v[4:7], v[148:151], 0
    s_waitcnt vmcnt(2)
    s_cbranch_vccz L_th_24
    s_waitcnt vmcnt(1)
L_th_24:
    buffer_load_dwordx4 v[164:167], v1, s[56:59], s5 offen offset:128 nt
    s_waitcnt lgkmcnt(0)
    v_cmp_gt_u32 vcc, 65, v48
    v_mov_b32 v48, 65
    ds_write_b32 v49, v48 offset:1544
    ds_read_b32 v48, v50 offset:1552
    v_mfma_f32_16x16x32_bf16 v[16:19], v[8:11], v[152:155], v[16:19]
    s_waitcnt vmcnt(2)
    s_cbranch_vccz L_th_25
    s_waitcnt vmcnt(1)
L_th_25:
    buffer_load_dwordx4 v[52:55], v1, s[56:59], s5 offen offset:256 nt
    s_add_u32 s5, s5, 393216
    s_cmp_ge_u32 s5, s6
    s_cselect_b32 s5, s4, s5
    s_waitcnt lgkmcnt(0)
    v_cmp_gt_u32 vcc, 66, v48
    v_mov_b32 v48, 66
    ds_write_b32 v49, v48 offset:1544
    ds_read_b32 v48, v50 offset:1552
    v_mfma_f32_16x16x32_bf16 v[16:19], v[12:15], v[156:159], v[16:19]
    v_cndmask_b32_e64 v2, v20, v21, s[8:9]
    s_nop 1
    v_add_f32_dpp v28, v2, v2 quad_perm:[1,0,3,2] row_mask:8 bank_mask:0xf
    v_cvt_pk_bf16_f32 v28, v28, v28
    v_and_b32 v28, 0xffff0000, v28
    v_mul_f32 v28, 0x3d93cd3a, v28
    v_cvt_pk_bf16_f32 v28, v28, v28
    v_and_b32 v28, 0xffff0000, v28
    s_waitcnt vmcnt(2)
    s_cbranch_vccz L_th_26
    s_waitcnt vmcnt(1)
L_th_26:
    buffer_load_dwordx4 v[56:59], v1, s[56:59], s5 offen offset:0 nt
    s_waitcnt lgkmcnt(0)
    v_cmp_gt_u32 vcc, 67, v48
    v_mov_b32 v48, 67
    ds_write_b32 v49, v48 offset:1544
    ds_read_b32 v48, v50 offset:1552
    v_mfma_f32_16x16x32_bf16 v[20:23], v[4:7], v[160:163], 0
    s_waitcnt vmcnt(2)
    s_cbranch_vccz L_th_27
    s_waitcnt vmcnt(1)
L_th_27:
    buffer_load_dwordx4 v[60:63], v1, s[56:59], s5 offen offset:128 nt
    s_waitcnt lgkmcnt(0)
    v_cmp_gt_u32 vcc, 68, v48
    v_mov_b32 v48, 68
    ds_write_b32 v49, v48 offset:1544
    ds_read_b32 v48, v50 offset:1552
    v_mfma_f32_16x16x32_bf16 v[20:23], v[8:11], v[164:167], v[20:23]
    s_waitcnt vmcnt(2)
    s_cbranch_vccz L_th_28
    s_waitcnt vmcnt(1)
L_th_28:
    buffer_load_dwordx4 v[64:67], v1, s[56:59], s5 offen offset:256 nt
    s_add_u32 s5, s5, 393216
    s_cmp_ge_u32 s5, s6
    s_cselect_b32 s5, s4, s5
    s_waitcnt lgkmcnt(0)
    v_cmp_gt_u32 vcc, 69, v48
    v_mov_b32 v48, 69
    ds_write_b32 v49, v48 offset:1544
    ds_read_b32 v48, v50 offset:1552
    v_mfma_f32_16x16x32_bf16 v[20:23], v[12:15], v[52:55], v[20:23]
    v_cndmask_b32_e64 v2, v16, v17, s[8:9]
    s_nop 1
    v_add_f32_dpp v29, v2, v2 quad_perm:[1,0,3,2] row_mask:1 bank_mask:0xf
    s_waitcnt vmcnt(2)
    s_cbranch_vccz L_th_29
    s_waitcnt vmcnt(1)
L_th_29:
    buffer_load_dwordx4 v[68:71], v1, s[56:59], s5 offen offset:0 nt
    s_waitcnt lgkmcnt(0)
    v_cmp_gt_u32 vcc, 70, v48
    v_mov_b32 v48, 70
    ds_write_b32 v49, v48 offset:1544
    ds_read_b32 v48, v50 offset:1552
    v_mfma_f32_16x16x32_bf16 v[16:19], v[4:7], v[56:59], 0
    s_waitcnt vmcnt(2)
    s_cbranch_vccz L_th_30
    s_waitcnt vmcnt(1)
L_th_30:
    buffer_load_dwordx4 v[72:75], v1, s[56:59], s5 offen offset:128 nt
    s_waitcnt lgkmcnt(0)
    v_cmp_gt_u32 vcc, 71, v48
    v_mov_b32 v48, 71
    ds_write_b32 v49, v48 offset:1544
    ds_read_b32 v48, v50 offset:1552
    v_mfma_f32_16x16x32_bf16 v[16:19], v[8:11], v[60:63], v[16:19]
    s_waitcnt vmcnt(2)
    s_cbranch_vccz L_th_31
    s_waitcnt vmcnt(1)
L_th_31:
    buffer_load_dwordx4 v[76:79], v1, s[56:59], s5 offen offset:256 nt
    s_add_u32 s5, s5, 393216
    s_cmp_ge_u32 s5, s6
    s_cselect_b32 s5, s4, s5
    s_add_u32 s4, s4, 50331648
    s_add_u32 s5, s5, 50331648
    s_add_u32 s6, s6, 50331648
    s_waitcnt lgkmcnt(0)
    v_cmp_gt_u32 vcc, 72, v48
    v_mov_b32 v48, 72
    ds_write_b32 v49, v48 offset:1544
    ds_read_b32 v48, v50 offset:1552
    v_mfma_f32_16x16x32_bf16 v[16:19], v[12:15], v[64:67], v[16:19]
    v_cndmask_b32_e64 v2, v20, v21, s[8:9]
    s_nop 1
    v_add_f32_dpp v29, v2, v2 quad_perm:[1,0,3,2] row_mask:2 bank_mask:0xf
    s_waitcnt vmcnt(2)
    s_cbranch_vccz L_th_32
    s_waitcnt vmcnt(1)
L_th_32:
    buffer_load_dwordx4 v[80:83], v1, s[56:59], s5 offen offset:0 nt
    s_waitcnt lgkmcnt(0)
    v_cmp_gt_u32 vcc, 73, v48
    v_mov_b32 v48, 73
    ds_write_b32 v49, v48 offset:1544
    ds_read_b32 v48, v50 offset:1552
    v_mfma_f32_16x16x32_bf16 v[20:23], v[4:7], v[68:71], 0
    s_waitcnt vmcnt(2)
    s_cbranch_vccz L_th_33
    s_waitcnt vmcnt(1)
L_th_33:
    buffer_load_dwordx4 v[84:87], v1, s[56:59], s5 offen offset:128 nt
    s_waitcnt lgkmcnt(0)
    v_cmp_gt_u32 vcc, 74, v48
    v_mov_b32 v48, 74
    ds_write_b32 v49, v48 offset:1544
    ds_read_b32 v48, v50 offset:1552
    v_mfma_f32_16x16x32_bf16 v[20:23], v[8:11], v[72:75], v[20:23]
    s_waitcnt vmcnt(2)
    s_cbranch_vccz L_th_34
    s_waitcnt vmcnt(1)
L_th_34:
    buffer_load_dwordx4 v[88:91], v1, s[56:59], s5 offen offset:256 nt
    s_add_u32 s5, s5, 393216
    s_cmp_ge_u32 s5, s6
    s_cselect_b32 s5, s4, s5
    s_waitcnt lgkmcnt(0)
    v_cmp_gt_u32 vcc, 75, v48
    v_mov_b32 v48, 75
    ds_write_b32 v49, v48 offset:1544
    ds_read_b32 v48, v50 offset:1552
    v_mfma_f32_16x16x32_bf16 v[20:23], v[12:15], v[76:79], v[20:23]
    v_cndmask_b32_e64 v2, v16, v17, s[8:9]
    s_nop 1
    v_add_f32_dpp v29, v2, v2 quad_perm:[1,0,3,2] row_mask:4 bank_mask:0xf
    ds_read_b128 v[4:7], v43 offset:384
    ds_read_b128 v[8:11], v43 offset:512
    ds_read_b128 v[12:15], v43 offset:640
    s_waitcnt lgkmcnt(0)
    s_waitcnt vmcnt(2)
    s_cbranch_vccz L_th_35
    s_waitcnt vmcnt(1)
L_th_35:
    buffer_load_dwordx4 v[92:95], v1, s[56:59], s5 offen offset:0 nt
    s_waitcnt lgkmcnt(0)
    v_cmp_gt_u32 vcc, 76, v48
    v_mov_b32 v48, 76
    ds_write_b32 v49, v48 offset:1544
    ds_read_b32 v48, v50 offset:1552
    v_mfma_f32_16x16x32_bf16 v[16:19], v[4:7], v[80:83], 0
    s_waitcnt vmcnt(2)
    s_cbranch_vccz L_th_36
    s_waitcnt vmcnt(1)
L_th_36:
    buffer_load_dwordx4 v[96:99], v1, s[56:59], s5 offen offset:128 nt
    s_waitcnt lgkmcnt(0)
    v_cmp_gt_u32 vcc, 77, v48
    v_mov_b32 v48, 77
    ds_write_b32 v49, v48 offset:1544
    ds_read_b32 v48, v50 offset:1552
    v_mfma_f32_16x16x32_bf16 v[16:19], v[8:11], v[84:87], v[16:19]
    s_waitcnt vmcnt(2)
    s_cbranch_vccz L_th_37
    s_waitcnt vmcnt(1)
L_th_37:
    buffer_load_dwordx4 v[100:103], v1, s[56:59], s5 offen offset:256 nt
    s_add_u32 s5, s5, 393216
    s_cmp_ge_u32 s5, s6
    s_cselect_b32 s5, s4, s5
    s_waitcnt lgkmcnt(0)
    v_cmp_gt_u32 vcc, 78, v48
    v_mov_b32 v48, 78
    ds_write_b32 v49, v48 offset:1544
    ds_read_b32 v48, v50 offset:1552
    v_mfma_f32_16x16x32_bf16 v[16:19], v[12:15], v[88:91], v[16:19]
    v_cndmask_b32_e64 v2, v20, v21, s[8:9]
    s_nop 1
    v_add_f32_dpp v29, v2, v2 quad_perm:[1,0,3,2] row_mask:8 bank_mask:0xf
    v_cvt_pk_bf16_f32 v29, v29, v29
    v_and_b32 v29, 0xffff0000, v29
    v_mul_f32 v29, 0x3d93cd3a, v29
    v_cvt_pk_bf16_f32 v29, v29, v29
    v_and_b32 v29, 0xffff0000, v29
    v_max_f32 v3, v28, v29
    s_nop 1
    v_max_f32_dpp v3, v3, v3 quad_perm:[2,3,0,1] row_mask:0xf bank_mask:0xf
    s_nop 1
    v_max_f32_dpp v3, v3, v3 row_half_mirror row_mask:0xf bank_mask:0xf
    s_nop 1
    v_max_f32_dpp v3, v3, v3 row_mirror row_mask:0xf bank_mask:0xf
    v_mov_b32 v32, v3
    s_nop 1
    v_permlane16_swap_b32 v3, v32
    v_max_f32 v3, v3, v32
    v_mov_b32 v32, v3
    s_nop 1
    v_permlane32_swap_b32 v3, v32
    v_max_f32 v3, v3, v32
    s_mov_b32 s10, 0x3fb8aa3b
    v_mul_f32 v32, s10, v3
    v_fma_f32 v28, v28, s10, -v32
    v_fma_f32 v29, v29, s10, -v32
    v_exp_f32 v28, v28
    v_exp_f32 v29, v29
    v_mov_b32_dpp v44, v3 quad_perm:[0,1,2,3] row_mask:1 bank_mask:0xf
    v_add_f32 v34, v28, v29
    v_cvt_pk_bf16_f32 v28, v28, v28
    v_cvt_pk_bf16_f32 v29, v29, v29
    v_add_f32_dpp v34, v34, v34 quad_perm:[2,3,0,1] row_mask:0xf bank_mask:0xf
    s_nop 1
    v_add_f32_dpp v34, v34, v34 row_half_mirror row_mask:0xf bank_mask:0xf
    s_nop 1
    v_add_f32_dpp v34, v34, v34 row_mirror row_mask:0xf bank_mask:0xf
    v_mov_b32 v32, v34
    s_nop 1
    v_permlane16_swap_b32 v34, v32
    v_add_f32 v34, v34, v32
    v_mov_b32 v32, v34
    s_nop 1
    v_permlane32_swap_b32 v34, v32
    v_add_f32 v34, v34, v32
    s_nop 1
    v_mov_b32_dpp v45, v34 quad_perm:[0,1,2,3] row_mask:1 bank_mask:0xf
    s_waitcnt vmcnt(2)
    s_cbranch_vccz L_th_38
    s_waitcnt vmcnt(1)
L_th_38:
    buffer_load_dwordx4 v[104:107], v1, s[56:59], s5 offen offset:0 nt
    s_waitcnt lgkmcnt(0)
    v_cmp_gt_u32 vcc, 79, v48
    v_mov_b32 v48, 79
    ds_write_b32 v49, v48 offset:1544
    ds_read_b32 v48, v50 offset:1552
    v_mfma_f32_16x16x32_bf16 v[20:23], v[4:7], v[92:95], 0
    s_waitcnt vmcnt(2)
    s_cbranch_vccz L_th_39
    s_waitcnt vmcnt(1)
L_th_39:
    buffer_load_dwordx4 v[108:111], v1, s[56:59], s5 offen offset:128 nt
    s_waitcnt lgkmcnt(0)
    v_cmp_gt_u32 vcc, 80, v48
    v_mov_b32 v48, 80
    ds_write_b32 v49, v48 offset:1544
    ds_read_b32 v48, v50 offset:1552
    v_mfma_f32_16x16x32_bf16 v[20:23], v[8:11], v[96:99], v[20:23]
    s_waitcnt vmcnt(2)
    s_cbranch_vccz L_th_40
    s_waitcnt vmcnt(1)
L_th_40:
    buffer_load_dwordx4 v[112:115], v1, s[56:59], s5 offen offset:256 nt
    s_add_u32 s5, s5, 393216
    s_cmp_ge_u32 s5, s6
    s_cselect_b32 s5, s4, s5
    s_waitcnt lgkmcnt(0)
    v_cmp_gt_u32 vcc, 81, v48
    v_mov_b32 v48, 81
    ds_write_b32 v49, v48 offset:1544
    ds_read_b32 v48, v50 offset:1552
    v_mfma_f32_16x16x32_bf16 v[20:23], v[12:15], v[100:103], v[20:23]
    v_cndmask_b32_e64 v2, v16, v17, s[8:9]
    s_nop 1
    v_add_f32_dpp v30, v2, v2 quad_perm:[1,0,3,2] row_mask:1 bank_mask:0xf
    s_waitcnt vmcnt(2)
    s_cbranch_vccz L_th_41
    s_waitcnt vmcnt(1)
L_th_41:
    buffer_load_dwordx4 v[116:119], v1, s[56:59], s5 offen offset:0 nt
    s_waitcnt lgkmcnt(0)
    v_cmp_gt_u32 vcc, 82, v48
    v_mov_b32 v48, 82
    ds_write_b32 v49, v48 offset:1544
    ds_read_b32 v48, v50 offset:1552
    v_mfma_f32_16x16x32_bf16 v[16:19], v[4:7], v[104:107], 0
    s_waitcnt vmcnt(2)
    s_cbranch_vccz L_th_42
    s_waitcnt vmcnt(1)
L_th_42:
    buffer_load_dwordx4 v[120:123], v1, s[56:59], s5 offen offset:128 nt
    s_waitcnt lgkmcnt(0)
    v_cmp_gt_u32 vcc, 83, v48
    v_mov_b32 v48, 83
    ds_write_b32 v49, v48 offset:1544
    ds_read_b32 v48, v50 offset:1552
    v_mfma_f32_16x16x32_bf16 v[16:19], v[8:11], v[108:111], v[16:19]
    s_waitcnt vmcnt(2)
    s_cbranch_vccz L_th_43
    s_waitcnt vmcnt(1)
L_th_43:
    buffer_load_dwordx4 v[124:127], v1, s[56:59], s5 offen offset:256 nt
    s_add_u32 s5, s5, 393216
    s_cmp_ge_u32 s5, s6
    s_cselect_b32 s5, s4, s5
    s_waitcnt lgkmcnt(0)
    v_cmp_gt_u32 vcc, 84, v48
    v_mov_b32 v48, 84
    ds_write_b32 v49, v48 offset:1544
    ds_read_b32 v48, v50 offset:1552
    v_mfma_f32_16x16x32_bf16 v[16:19], v[12:15], v[112:115], v[16:19]
    v_cndmask_b32_e64 v2, v20, v21, s[8:9]
    s_nop 1
    v_add_f32_dpp v30, v2, v2 quad_perm:[1,0,3,2] row_mask:2 bank_mask:0xf
    s_waitcnt vmcnt(2)
    s_cbranch_vccz L_th_44
    s_waitcnt vmcnt(1)
L_th_44:
    buffer_load_dwordx4 v[128:131], v1, s[56:59], s5 offen offset:0 nt
    s_waitcnt lgkmcnt(0)
    v_cmp_gt_u32 vcc, 85, v48
    v_mov_b32 v48, 85
    ds_write_b32 v49, v48 offset:1544
    ds_read_b32 v48, v50 offset:1552
    v_mfma_f32_16x16x32_bf16 v[20:23], v[4:7], v[116:119], 0
    s_waitcnt vmcnt(2)
    s_cbranch_vccz L_th_45
    s_waitcnt vmcnt(1)
L_th_45:
    buffer_load_dwordx4 v[132:135], v1, s[56:59], s5 offen offset:128 nt
    s_waitcnt lgkmcnt(0)
    v_cmp_gt_u32 vcc, 86, v48
    v_mov_b32 v48, 86
    ds_write_b32 v49, v48 offset:1544
    ds_read_b32 v48, v50 offset:1552
    v_mfma_f32_16x16x32_bf16 v[20:23], v[8:11], v[120:123], v[20:23]
    s_waitcnt vmcnt(2)
    s_cbranch_vccz L_th_46
    s_waitcnt vmcnt(1)
L_th_46:
    buffer_load_dwordx4 v[136:139], v1, s[56:59], s5 offen offset:256 nt
    s_add_u32 s5, s5, 393216
    s_cmp_ge_u32 s5, s6
    s_cselect_b32 s5, s4, s5
    s_waitcnt lgkmcnt(0)
    v_cmp_gt_u32 vcc, 87, v48
    v_mov_b32 v48, 87
    ds_write_b32 v49, v48 offset:1544
    ds_read_b32 v48, v50 offset:1552
    v_mfma_f32_16x16x32_bf16 v[20:23], v[12:15], v[124:127], v[20:23]
    v_cndmask_b32_e64 v2, v16, v17, s[8:9]
    s_nop 1
    v_add_f32_dpp v30, v2, v2 quad_perm:[1,0,3,2] row_mask:4 bank_mask:0xf
    s_waitcnt vmcnt(2)
    s_cbranch_vccz L_th_47
    s_waitcnt vmcnt(1)
L_th_47:
    buffer_load_dwordx4 v[140:143], v1, s[56:59], s5 offen offset:0 nt
    s_waitcnt lgkmcnt(0)
    v_cmp_gt_u32 vcc, 88, v48
    v_mov_b32 v48, 88
    ds_write_b32 v49, v48 offset:1544
    ds_read_b32 v48, v50 offset:1552
    v_mfma_f32_16x16x32_bf16 v[16:19], v[4:7], v[128:131], 0
    s_waitcnt vmcnt(2)
    s_cbranch_vccz L_th_48
    s_waitcnt vmcnt(1)
L_th_48:
    buffer_load_dwordx4 v[144:147], v1, s[56:59], s5 offen offset:128 nt
    s_waitcnt lgkmcnt(0)
    v_cmp_gt_u32 vcc, 89, v48
    v_mov_b32 v48, 89
    ds_write_b32 v49, v48 offset:1544
    ds_read_b32 v48, v50 offset:1552
    v_mfma_f32_16x16x32_bf16 v[16:19], v[8:11], v[132:135], v[16:19]
    s_waitcnt vmcnt(2)
    s_cbranch_vccz L_th_49
    s_waitcnt vmcnt(1)
L_th_49:
    buffer_load_dwordx4 v[148:151], v1, s[56:59], s5 offen offset:256 nt
    s_add_u32 s5, s5, 393216
    s_cmp_ge_u32 s5, s6
    s_cselect_b32 s5, s4, s5
    s_waitcnt lgkmcnt(0)
    v_cmp_gt_u32 vcc, 90, v48
    v_mov_b32 v48, 90
    ds_write_b32 v49, v48 offset:1544
    ds_read_b32 v48, v50 offset:1552
    v_mfma_f32_16x16x32_bf16 v[16:19], v[12:15], v[136:139], v[16:19]
    v_cndmask_b32_e64 v2, v20, v21, s[8:9]
    s_nop 1
    v_add_f32_dpp v30, v2, v2 quad_perm:[1,0,3,2] row_mask:8 bank_mask:0xf
    v_cvt_pk_bf16_f32 v30, v30, v30
    v_and_b32 v30, 0xffff0000, v30
    v_mul_f32 v30, 0x3d93cd3a, v30
    v_cvt_pk_bf16_f32 v30, v30, v30
    v_and_b32 v30, 0xffff0000, v30
    s_waitcnt vmcnt(2)
    s_cbranch_vccz L_th_50
    s_waitcnt vmcnt(1)
L_th_50:
    buffer_load_dwordx4 v[152:155], v1, s[56:59], s5 offen offset:0 nt
    s_waitcnt lgkmcnt(0)
    v_cmp_gt_u32 vcc, 91, v48
    v_mov_b32 v48, 91
    ds_write_b32 v49, v48 offset:1544
    ds_read_b32 v48, v50 offset:1552
    v_mfma_f32_16x16x32_bf16 v[20:23], v[4:7], v[140:143], 0
    s_waitcnt vmcnt(2)
    s_cbranch_vccz L_th_51
    s_waitcnt vmcnt(1)
L_th_51:
    buffer_load_dwordx4 v[156:159], v1, s[56:59], s5 offen offset:128 nt
    s_waitcnt lgkmcnt(0)
    v_cmp_gt_u32 vcc, 92, v48
    v_mov_b32 v48, 92
    ds_write_b32 v49, v48 offset:1544
    ds_read_b32 v48, v50 offset:1552
    v_mfma_f32_16x16x32_bf16 v[20:23], v[8:11], v[144:147], v[20:23]
    s_waitcnt vmcnt(2)
    s_cbranch_vccz L_th_52
    s_waitcnt vmcnt(1)
L_th_52:
    buffer_load_dwordx4 v[160:163], v1, s[56:59], s5 offen offset:256 nt
    s_add_u32 s5, s5, 393216
    s_cmp_ge_u32 s5, s6
    s_cselect_b32 s5, s4, s5
    s_waitcnt lgkmcnt(0)
    v_cmp_gt_u32 vcc, 93, v48
    v_mov_b32 v48, 93
    ds_write_b32 v49, v48 offset:1544
    ds_read_b32 v48, v50 offset:1552
    v_mfma_f32_16x16x32_bf16 v[20:23], v[12:15], v[148:151], v[20:23]
    v_cndmask_b32_e64 v2, v16, v17, s[8:9]
    s_nop 1
    v_add_f32_dpp v31, v2, v2 quad_perm:[1,0,3,2] row_mask:1 bank_mask:0xf
    s_waitcnt vmcnt(2)
    s_cbranch_vccz L_th_53
    s_waitcnt vmcnt(1)
L_th_53:
    buffer_load_dwordx4 v[164:167], v1, s[56:59], s5 offen offset:0 nt
    s_waitcnt lgkmcnt(0)
    v_cmp_gt_u32 vcc, 94, v48
    v_mov_b32 v48, 94
    ds_write_b32 v49, v48 offset:1544
    ds_read_b32 v48, v50 offset:1552
    v_mfma_f32_16x16x32_bf16 v[16:19], v[4:7], v[152:155], 0
    s_waitcnt vmcnt(2)
    s_cbranch_vccz L_th_54
    s_waitcnt vmcnt(1)
L_th_54:
    buffer_load_dwordx4 v[52:55], v1, s[56:59], s5 offen offset:128 nt
    s_waitcnt lgkmcnt(0)
    v_cmp_gt_u32 vcc, 95, v48
    v_mov_b32 v48, 95
    ds_write_b32 v49, v48 offset:1544
    ds_read_b32 v48, v50 offset:1552
    v_mfma_f32_16x16x32_bf16 v[16:19], v[8:11], v[156:159], v[16:19]
    s_waitcnt vmcnt(2)
    s_cbranch_vccz L_th_55
    s_waitcnt vmcnt(1)
L_th_55:
    buffer_load_dwordx4 v[56:59], v1, s[56:59], s5 offen offset:256 nt
    s_add_u32 s5, s5, 393216
    s_cmp_ge_u32 s5, s6
    s_cselect_b32 s5, s4, s5
    s_sub_u32 s4, s4, 50331648
    s_sub_u32 s5, s5, 50331648
    s_sub_u32 s6, s6, 50331648
    s_waitcnt lgkmcnt(0)
    v_cmp_gt_u32 vcc, 96, v48
    v_mov_b32 v48, 96
    ds_write_b32 v49, v48 offset:1544
    ds_read_b32 v48, v50 offset:1552
    v_mfma_f32_16x16x32_bf16 v[16:19], v[12:15], v[160:163], v[16:19]
    v_cndmask_b32_e64 v2, v20, v21, s[8:9]
    s_nop 1
    v_add_f32_dpp v31, v2, v2 quad_perm:[1,0,3,2] row_mask:2 bank_mask:0xf
    s_waitcnt vmcnt(2)
    s_cbranch_vccz L_th_56
    s_waitcnt vmcnt(1)
L_th_56:
    buffer_load_dwordx4 v[60:63], v40, s[60:63], s5 offen offset:0 nt
    s_waitcnt lgkmcnt(0)
    v_cmp_gt_u32 vcc, 97, v48
    v_mov_b32 v48, 97
    ds_write_b32 v49, v48 offset:1544
    ds_read_b32 v48, v50 offset:1552
    v_mfma_f32_16x16x32_bf16 v[20:23], v[4:7], v[164:167], 0
    s_waitcnt vmcnt(2)
    s_cbranch_vccz L_th_57
    s_waitcnt vmcnt(1)
L_th_57:
    buffer_load_dwordx4 v[64:67], v40, s[60:63], s5 offen offset:128 nt
    s_waitcnt lgkmcnt(0)
    v_cmp_gt_u32 vcc, 98, v48
    v_mov_b32 v48, 98
    ds_write_b32 v49, v48 offset:1544
    ds_read_b32 v48, v50 offset:1552
    v_mfma_f32_16x16x32_bf16 v[20:23], v[8:11], v[52:55], v[20:23]
    s_waitcnt vmcnt(2)
    s_cbranch_vccz L_th_58
    s_waitcnt vmcnt(1)
L_th_58:
    buffer_load_dwordx4 v[68:71], v40, s[60:63], s5 offen offset:256 nt
    s_add_u32 s5, s5, 393216
    s_cmp_ge_u32 s5, s6
    s_cselect_b32 s5, s4, s5
    s_waitcnt lgkmcnt(0)
    v_cmp_gt_u32 vcc, 99, v48
    v_mov_b32 v48, 99
    ds_write_b32 v49, v48 offset:1544
    ds_read_b32 v48, v50 offset:1552
    v_mfma_f32_16x16x32_bf16 v[20:23], v[12:15], v[56:59], v[20:23]
    v_cndmask_b32_e64 v2, v16, v17, s[8:9]
    s_nop 1
    v_add_f32_dpp v31, v2, v2 quad_perm:[1,0,3,2] row_mask:4 bank_mask:0xf
    s_nop 3
    v_cndmask_b32_e64 v2, v20, v21, s[8:9]
    s_nop 1
    v_add_f32_dpp v31, v2, v2 quad_perm:[1,0,3,2] row_mask:8 bank_mask:0xf
    v_cvt_pk_bf16_f32 v31, v31, v31
    v_and_b32 v31, 0xffff0000, v31
    v_mul_f32 v31, 0x3d93cd3a, v31
    v_cvt_pk_bf16_f32 v31, v31, v31
    v_and_b32 v31, 0xffff0000, v31
    v_max_f32 v3, v30, v31
    s_nop 1
    v_max_f32_dpp v3, v3, v3 quad_perm:[2,3,0,1] row_mask:0xf bank_mask:0xf
    s_nop 1
    v_max_f32_dpp v3, v3, v3 row_half_mirror row_mask:0xf bank_mask:0xf
    s_nop 1
    v_max_f32_dpp v3, v3, v3 row_mirror row_mask:0xf bank_mask:0xf
    v_mov_b32 v32, v3
    s_nop 1
    v_permlane16_swap_b32 v3, v32
    v_max_f32 v3, v3, v32
    v_mov_b32 v32, v3
    s_nop 1
    v_permlane32_swap_b32 v3, v32
    v_max_f32 v3, v3, v32
    s_mov_b32 s10, 0x3fb8aa3b
    v_mul_f32 v32, s10, v3
    v_fma_f32 v30, v30, s10, -v32
    v_fma_f32 v31, v31, s10, -v32
    v_exp_f32 v30, v30
    v_exp_f32 v31, v31
    v_mov_b32_dpp v44, v3 quad_perm:[0,1,2,3] row_mask:2 bank_mask:0xf
    v_add_f32 v34, v30, v31
    v_cvt_pk_bf16_f32 v30, v30, v30
    v_cvt_pk_bf16_f32 v31, v31, v31
    v_add_f32_dpp v34, v34, v34 quad_perm:[2,3,0,1] row_mask:0xf bank_mask:0xf
    s_nop 1
    v_add_f32_dpp v34, v34, v34 row_half_mirror row_mask:0xf bank_mask:0xf
    s_nop 1
    v_add_f32_dpp v34, v34, v34 row_mirror row_mask:0xf bank_mask:0xf
    v_mov_b32 v32, v34
    s_nop 1
    v_permlane16_swap_b32 v34, v32
    v_add_f32 v34, v34, v32
    v_mov_b32 v32, v34
    s_nop 1
    v_permlane32_swap_b32 v34, v32
    v_add_f32 v34, v34, v32
    s_nop 1
    v_mov_b32_dpp v45, v34 quad_perm:[0,1,2,3] row_mask:2 bank_mask:0xf
    ds_bpermute_b32 v35, v41, v28 offset:0
    v_bitop3_b32 v46, v44, v45, s44 bitop3:0x96
    v_lshlrev_b32 v47, 7, v0
    s_lshr_b32 s10, s45, 1
    s_lshl_b32 s10, s10, 9
    s_add_u32 s10, s10, s7
    s_lshl_b32 s10, s10, 4
    s_add_u32 s10, s10, 1572864
    s_mov_b32 exec_lo, 0x00010001
    s_mov_b32 exec_hi, 0x00010001
    s_cmp_eq_u32 s50, 1
    s_cbranch_scc1 L_pl_59
    buffer_store_dwordx4 v[44:47], v47, s[52:55], s10 offen sc1
    s_branch L_st_60
L_pl_59:
    buffer_store_dwordx4 v[44:47], v47, s[52:55], s10 offen
L_st_60:
    s_mov_b64 exec, -1
    v_lshrrev_b32 v32, 5, v0
    v_mul_u32_u24 v32, 768, v32
    v_and_b32 v33, 7, v0
    v_lshl_add_u32 v32, v33, 5, v32
    v_and_b32 v33, 16, v0
    v_add_u32 v32, v32, v33
    s_mul_i32 s10, s3, 1536
    s_add_u32 s10, s10, 9216
    v_add_u32 v32, s10, v32
    s_waitcnt vmcnt(2)
    s_cbranch_vccz L_th_61
    s_waitcnt vmcnt(1)
L_th_61:
    buffer_load_dwordx4 v[72:75], v40, s[60:63], s5 offen offset:0 nt
    s_waitcnt lgkmcnt(0)
    v_cmp_gt_u32 vcc, 100, v48
    v_mov_b32 v48, 100
    ds_write_b32 v49, v48 offset:1544
    ds_read_b32 v48, v50 offset:1552
    s_waitcnt lgkmcnt(0)
    v_and_b32 v16, v35, v36
    v_and_b32 v17, v35, v37
    v_and_b32 v18, v35, v38
    v_and_b32 v19, v35, v39
    ds_bpermute_b32 v42, v41, v28 offset:64
    s_nop 0
    v_mfma_f32_16x16x32_bf16 v[4:7], v[16:19], v[60:63], 0
    v_mfma_f32_16x16x32_bf16 v[8:11], v[16:19], v[64:67], 0
    s_waitcnt vmcnt(2)
    s_cbranch_vccz L_th_62
    s_waitcnt vmcnt(1)
L_th_62:
    buffer_load_dwordx4 v[76:79], v40, s[60:63], s5 offen offset:128 nt
    s_waitcnt lgkmcnt(0)
    v_cmp_gt_u32 vcc, 101, v48
    v_mov_b32 v48, 101
    ds_write_b32 v49, v48 offset:1544
    ds_read_b32 v48, v50 offset:1552
    v_mfma_f32_16x16x32_bf16 v[12:15], v[16:19], v[68:71], 0
    s_waitcnt vmcnt(2)
    s_cbranch_vccz L_th_63
    s_waitcnt vmcnt(1)
L_th_63:
    buffer_load_dwordx4 v[80:83], v40, s[60:63], s5 offen offset:256 nt
    s_add_u32 s5, s5, 393216
    s_cmp_ge_u32 s5, s6
    s_cselect_b32 s5, s4, s5
    s_waitcnt lgkmcnt(0)
    v_cmp_gt_u32 vcc, 102, v48
    v_mov_b32 v48, 102
    ds_write_b32 v49, v48 offset:1544
    ds_read_b32 v48, v50 offset:1552
    s_waitcnt vmcnt(2)
    s_cbranch_vccz L_th_64
    s_waitcnt vmcnt(1)
L_th_64:
    buffer_load_dwordx4 v[84:87], v40, s[60:63], s5 offen offset:0 nt
    s_waitcnt lgkmcnt(0)
    v_cmp_gt_u32 vcc, 103, v48
    v_mov_b32 v48, 103
    ds_write_b32 v49, v48 offset:1544
    ds_read_b32 v48, v50 offset:1552
    s_waitcnt lgkmcnt(0)
    v_and_b32 v20, v42, v36
    v_and_b32 v21, v42, v37
    v_and_b32 v22, v42, v38
    v_and_b32 v23, v42, v39
    ds_bpermute_b32 v35, v41, v28 offset:128
    s_nop 0
    v_mfma_f32_16x16x32_bf16 v[4:7], v[20:23], v[72:75], v[4:7]
    s_waitcnt vmcnt(2)
    s_cbranch_vccz L_th_65
    s_waitcnt vmcnt(1)
L_th_65:
    buffer_load_dwordx4 v[88:91], v40, s[60:63], s5 offen offset:128 nt
    s_waitcnt lgkmcnt(0)
    v_cmp_gt_u32 vcc, 104, v48
    v_mov_b32 v48, 104
    ds_write_b32 v49, v48 offset:1544
    ds_read_b32 v48, v50 offset:1552
    v_mfma_f32_16x16x32_bf16 v[8:11], v[20:23], v[76:79], v[8:11]
    s_waitcnt vmcnt(2)
    s_cbranch_vccz L_th_66
    s_waitcnt vmcnt(1)
L_th_66:
    buffer_load_dwordx4 v[92:95], v40, s[60:63], s5 offen offset:256 nt
    s_add_u32 s5, s5, 393216
    s_cmp_ge_u32 s5, s6
    s_cselect_b32 s5, s4, s5
    s_waitcnt lgkmcnt(0)
    v_cmp_gt_u32 vcc, 105, v48
    v_mov_b32 v48, 105
    ds_write_b32 v49, v48 offset:1544
    ds_read_b32 v48, v50 offset:1552
    v_mfma_f32_16x16x32_bf16 v[12:15], v[20:23], v[80:83], v[12:15]
    s_waitcnt vmcnt(2)
    s_cbranch_vccz L_th_67
    s_waitcnt vmcnt(1)
L_th_67:
    buffer_load_dwordx4 v[96:99], v40, s[60:63], s5 offen offset:0 nt
    s_waitcnt lgkmcnt(0)
    v_cmp_gt_u32 vcc, 106, v48
    v_mov_b32 v48, 106
    ds_write_b32 v49, v48 offset:1544
    ds_read_b32 v48, v50 offset:1552
    s_waitcnt lgkmcnt(0)
    v_and_b32 v16, v35, v36
    v_and_b32 v17, v35, v37
    v_and_b32 v18, v35, v38
    v_and_b32 v19, v35, v39
    ds_bpermute_b32 v42, v41, v28 offset:192
    s_nop 0
    v_mfma_f32_16x16x32_bf16 v[4:7], v[16:19], v[84:87], v[4:7]
    s_waitcnt vmcnt(2)
    s_cbranch_vccz L_th_68
    s_waitcnt vmcnt(1)
L_th_68:
    buffer_load_dwordx4 v[100:103], v40, s[60:63], s5 offen offset:128 nt
    s_waitcnt lgkmcnt(0)
    v_cmp_gt_u32 vcc, 107, v48
    v_mov_b32 v48, 107
    ds_write_b32 v49, v48 offset:1544
    ds_read_b32 v48, v50 offset:1552
    v_mfma_f32_16x16x32_bf16 v[8:11], v[16:19], v[88:91], v[8:11]
    s_waitcnt vmcnt(2)
    s_cbranch_vccz L_th_69
    s_waitcnt vmcnt(1)
L_th_69:
    buffer_load_dwordx4 v[104:107], v40, s[60:63], s5 offen offset:256 nt
    s_add_u32 s5, s5, 393216
    s_cmp_ge_u32 s5, s6
    s_cselect_b32 s5, s4, s5
    s_waitcnt lgkmcnt(0)
    v_cmp_gt_u32 vcc, 108, v48
    v_mov_b32 v48, 108
    ds_write_b32 v49, v48 offset:1544
    ds_read_b32 v48, v50 offset:1552
    v_mfma_f32_16x16x32_bf16 v[12:15], v[16:19], v[92:95], v[12:15]
    s_waitcnt vmcnt(2)
    s_cbranch_vccz L_th_70
    s_waitcnt vmcnt(1)
L_th_70:
    buffer_load_dwordx4 v[108:111], v40, s[60:63], s5 offen offset:0 nt
    s_waitcnt lgkmcnt(0)
    v_cmp_gt_u32 vcc, 109, v48
    v_mov_b32 v48, 109
    ds_write_b32 v49, v48 offset:1544
    ds_read_b32 v48, v50 offset:1552
    s_waitcnt lgkmcnt(0)
    v_and_b32 v20, v42, v36
    v_and_b32 v21, v42, v37
    v_and_b32 v22, v42, v38
    v_and_b32 v23, v42, v39
    ds_bpermute_b32 v35, v41, v29 offset:0
    s_nop 0
    v_mfma_f32_16x16x32_bf16 v[4:7], v[20:23], v[96:99], v[4:7]
    s_waitcnt vmcnt(2)
    s_cbranch_vccz L_th_71
    s_waitcnt vmcnt(1)
L_th_71:
    buffer_load_dwordx4 v[112:115], v40, s[60:63], s5 offen offset:128 nt
    s_waitcnt lgkmcnt(0)
    v_cmp_gt_u32 vcc, 110, v48
    v_mov_b32 v48, 110
    ds_write_b32 v49, v48 offset:1544
    ds_read_b32 v48, v50 offset:1552
    v_mfma_f32_16x16x32_bf16 v[8:11], v[20:23], v[100:103], v[8:11]
    s_waitcnt vmcnt(2)
    s_cbranch_vccz L_th_72
    s_waitcnt vmcnt(1)
L_th_72:
    buffer_load_dwordx4 v[116:119], v40, s[60:63], s5 offen offset:256 nt
    s_add_u32 s5, s5, 393216
    s_cmp_ge_u32 s5, s6
    s_cselect_b32 s5, s4, s5
    s_waitcnt lgkmcnt(0)
    v_cmp_gt_u32 vcc, 111, v48
    v_mov_b32 v48, 111
    ds_write_b32 v49, v48 offset:1544
    ds_read_b32 v48, v50 offset:1552
    v_mfma_f32_16x16x32_bf16 v[12:15], v[20:23], v[104:107], v[12:15]
    s_waitcnt vmcnt(2)
    s_cbranch_vccz L_th_73
    s_waitcnt vmcnt(1)
L_th_73:
    buffer_load_dwordx4 v[120:123], v40, s[60:63], s5 offen offset:0 nt
    s_waitcnt lgkmcnt(0)
    v_cmp_gt_u32 vcc, 112, v48
    v_mov_b32 v48, 112
    ds_write_b32 v49, v48 offset:1544
    ds_read_b32 v48, v50 offset:1552
    s_waitcnt lgkmcnt(0)
    v_and_b32 v16, v35, v36
    v_and_b32 v17, v35, v37
    v_and_b32 v18, v35, v38
    v_and_b32 v19, v35, v39
    ds_bpermute_b32 v42, v41, v29 offset:64
    s_nop 0
    v_mfma_f32_16x16x32_bf16 v[4:7], v[16:19], v[108:111], v[4:7]
    s_waitcnt vmcnt(2)
    s_cbranch_vccz L_th_74
    s_waitcnt vmcnt(1)
L_th_74:
    buffer_load_dwordx4 v[124:127], v40, s[60:63], s5 offen offset:128 nt
    s_waitcnt lgkmcnt(0)
    v_cmp_gt_u32 vcc, 113, v48
    v_mov_b32 v48, 113
    ds_write_b32 v49, v48 offset:1544
    ds_read_b32 v48, v50 offset:1552
    v_mfma_f32_16x16x32_bf16 v[8:11], v[16:19], v[112:115], v[8:11]
    s_waitcnt vmcnt(2)
    s_cbranch_vccz L_th_75
    s_waitcnt vmcnt(1)
L_th_75:
    buffer_load_dwordx4 v[128:131], v40, s[60:63], s5 offen offset:256 nt
    s_add_u32 s5, s5, 393216
    s_cmp_ge_u32 s5, s6
    s_cselect_b32 s5, s4, s5
    s_waitcnt lgkmcnt(0)
    v_cmp_gt_u32 vcc, 114, v48
    v_mov_b32 v48, 114
    ds_write_b32 v49, v48 offset:1544
    ds_read_b32 v48, v50 offset:1552
    v_mfma_f32_16x16x32_bf16 v[12:15], v[16:19], v[116:119], v[12:15]
    s_waitcnt vmcnt(2)
    s_cbranch_vccz L_th_76
    s_waitcnt vmcnt(1)
L_th_76:
    buffer_load_dwordx4 v[132:135], v40, s[60:63], s5 offen offset:0 nt
    s_waitcnt lgkmcnt(0)
    v_cmp_gt_u32 vcc, 115, v48
    v_mov_b32 v48, 115
    ds_write_b32 v49, v48 offset:1544
    ds_read_b32 v48, v50 offset:1552
    s_waitcnt lgkmcnt(0)
    v_and_b32 v20, v42, v36
    v_and_b32 v21, v42, v37
    v_and_b32 v22, v42, v38
    v_and_b32 v23, v42, v39
    ds_bpermute_b32 v35, v41, v29 offset:128
    s_nop 0
    v_mfma_f32_16x16x32_bf16 v[4:7], v[20:23], v[120:123], v[4:7]
    s_waitcnt vmcnt(2)
    s_cbranch_vccz L_th_77
    s_waitcnt vmcnt(1)
L_th_77:
    buffer_load_dwordx4 v[136:139], v40, s[60:63], s5 offen offset:128 nt
    s_waitcnt lgkmcnt(0)
    v_cmp_gt_u32 vcc, 116, v48
    v_mov_b32 v48, 116
    ds_write_b32 v49, v48 offset:1544
    ds_read_b32 v48, v50 offset:1552
    v_mfma_f32_16x16x32_bf16 v[8:11], v[20:23], v[124:127], v[8:11]
    s_waitcnt vmcnt(2)
    s_cbranch_vccz L_th_78
    s_waitcnt vmcnt(1)
L_th_78:
    buffer_load_dwordx4 v[140:143], v40, s[60:63], s5 offen offset:256 nt
    s_add_u32 s5, s5, 393216
    s_cmp_ge_u32 s5, s6
    s_cselect_b32 s5, s4, s5
    s_waitcnt lgkmcnt(0)
    v_cmp_gt_u32 vcc, 117, v48
    v_mov_b32 v48, 117
    ds_write_b32 v49, v48 offset:1544
    ds_read_b32 v48, v50 offset:1552
    v_mfma_f32_16x16x32_bf16 v[12:15], v[20:23], v[128:131], v[12:15]
    s_waitcnt vmcnt(2)
    s_cbranch_vccz L_th_79
    s_waitcnt vmcnt(1)
L_th_79:
    buffer_load_dwordx4 v[144:147], v40, s[60:63], s5 offen offset:0 nt
    s_waitcnt lgkmcnt(0)
    v_cmp_gt_u32 vcc, 118, v48
    v_mov_b32 v48, 118
    ds_write_b32 v49, v48 offset:1544
    ds_read_b32 v48, v50 offset:1552
    s_waitcnt lgkmcnt(0)
    v_and_b32 v16, v35, v36
    v_and_b32 v17, v35, v37
    v_and_b32 v18, v35, v38
    v_and_b32 v19, v35, v39
    ds_bpermute_b32 v42, v41, v29 offset:192
    s_nop 0
    v_mfma_f32_16x16x32_bf16 v[4:7], v[16:19], v[132:135], v[4:7]
    s_waitcnt vmcnt(2)
    s_cbranch_vccz L_th_80
    s_waitcnt vmcnt(1)
L_th_80:
    buffer_load_dwordx4 v[148:151], v40, s[60:63], s5 offen offset:128 nt
    s_waitcnt lgkmcnt(0)
    v_cmp_gt_u32 vcc, 119, v48
    v_mov_b32 v48, 119
    ds_write_b32 v49, v48 offset:1544
    ds_read_b32 v48, v50 offset:1552
    v_mfma_f32_16x16x32_bf16 v[8:11], v[16:19], v[136:139], v[8:11]
    s_waitcnt vmcnt(2)
    s_cbranch_vccz L_th_81
    s_waitcnt vmcnt(1)
L_th_81:
    buffer_load_dwordx4 v[152:155], v40, s[60:63], s5 offen offset:256 nt
    s_add_u32 s5, s5, 393216
    s_cmp_ge_u32 s5, s6
    s_cselect_b32 s5, s4, s5
    s_add_u32 s4, s4, 50331648
    s_add_u32 s5, s5, 50331648
    s_add_u32 s6, s6, 50331648
    s_waitcnt lgkmcnt(0)
    v_cmp_gt_u32 vcc, 120, v48
    v_mov_b32 v48, 120
    ds_write_b32 v49, v48 offset:1544
    ds_read_b32 v48, v50 offset:1552
    v_mfma_f32_16x16x32_bf16 v[12:15], v[16:19], v[140:143], v[12:15]
    s_waitcnt vmcnt(2)
    s_cbranch_vccz L_th_82
    s_waitcnt vmcnt(1)
L_th_82:
    buffer_load_dwordx4 v[156:159], v40, s[60:63], s5 offen offset:0 nt
    s_waitcnt lgkmcnt(0)
    v_cmp_gt_u32 vcc, 121, v48
    v_mov_b32 v48, 121
    ds_write_b32 v49, v48 offset:1544
    ds_read_b32 v48, v50 offset:1552
    s_waitcnt lgkmcnt(0)
    v_and_b32 v20, v42, v36
    v_and_b32 v21, v42, v37
    v_and_b32 v22, v42, v38
    v_and_b32 v23, v42, v39
    ds_bpermute_b32 v35, v41, v30 offset:0
    s_nop 0
    v_mfma_f32_16x16x32_bf16 v[4:7], v[20:23], v[144:147], v[4:7]
    s_waitcnt vmcnt(2)
    s_cbranch_vccz L_th_83
    s_waitcnt vmcnt(1)
L_th_83:
    buffer_load_dwordx4 v[160:163], v40, s[60:63], s5 offen offset:128 nt
    s_waitcnt lgkmcnt(0)
    v_cmp_gt_u32 vcc, 122, v48
    v_mov_b32 v48, 122
    ds_write_b32 v49, v48 offset:1544
    ds_read_b32 v48, v50 offset:1552
    v_mfma_f32_16x16x32_bf16 v[8:11], v[20:23], v[148:151], v[8:11]
    s_waitcnt vmcnt(2)
    s_cbranch_vccz L_th_84
    s_waitcnt vmcnt(1)
L_th_84:
    buffer_load_dwordx4 v[164:167], v40, s[60:63], s5 offen offset:256 nt
    s_add_u32 s5, s5, 393216
    s_cmp_ge_u32 s5, s6
    s_cselect_b32 s5, s4, s5
    s_waitcnt lgkmcnt(0)
    v_cmp_gt_u32 vcc, 123, v48
    v_mov_b32 v48, 123
    ds_write_b32 v49, v48 offset:1544
    ds_read_b32 v48, v50 offset:1552
    v_mfma_f32_16x16x32_bf16 v[12:15], v[20:23], v[152:155], v[12:15]
    s_waitcnt vmcnt(2)
    s_cbranch_vccz L_th_85
    s_waitcnt vmcnt(1)
L_th_85:
    buffer_load_dwordx4 v[52:55], v40, s[60:63], s5 offen offset:0 nt
    s_waitcnt lgkmcnt(0)
    v_cmp_gt_u32 vcc, 124, v48
    v_mov_b32 v48, 124
    ds_write_b32 v49, v48 offset:1544
    ds_read_b32 v48, v50 offset:1552
    s_waitcnt lgkmcnt(0)
    v_and_b32 v16, v35, v36
    v_and_b32 v17, v35, v37
    v_and_b32 v18, v35, v38
    v_and_b32 v19, v35, v39
    ds_bpermute_b32 v42, v41, v30 offset:64
    s_nop 0
    v_mfma_f32_16x16x32_bf16 v[152:155], v[16:19], v[156:159], 0
    s_waitcnt vmcnt(2)
    s_cbranch_vccz L_th_86
    s_waitcnt vmcnt(1)
L_th_86:
    buffer_load_dwordx4 v[56:59], v40, s[60:63], s5 offen offset:128 nt
    s_waitcnt lgkmcnt(0)
    v_cmp_gt_u32 vcc, 125, v48
    v_mov_b32 v48, 125
    ds_write_b32 v49, v48 offset:1544
    ds_read_b32 v48, v50 offset:1552
    v_mfma_f32_16x16x32_bf16 v[148:151], v[16:19], v[160:163], 0
    s_waitcnt vmcnt(2)
    s_cbranch_vccz L_th_87
    s_waitcnt vmcnt(1)
L_th_87:
    buffer_load_dwordx4 v[60:63], v40, s[60:63], s5 offen offset:256 nt
    s_add_u32 s5, s5, 393216
    s_cmp_ge_u32 s5, s6
    s_cselect_b32 s5, s4, s5
    s_waitcnt lgkmcnt(0)
    v_cmp_gt_u32 vcc, 126, v48
    v_mov_b32 v48, 126
    ds_write_b32 v49, v48 offset:1544
    ds_read_b32 v48, v50 offset:1552
    v_mfma_f32_16x16x32_bf16 v[144:147], v[16:19], v[164:167], 0
    s_mov_b32 exec_lo, 0x00ff00ff
    s_mov_b32 exec_hi, 0xff00ff00
    ds_write_b128 v32, v[4:7] offset:0
    ds_write_b128 v32, v[8:11] offset:256
    ds_write_b128 v32, v[12:15] offset:512
    s_mov_b64 exec, -1
    s_mov_b64 exec, 1
    v_mov_b32 v33, 1
    ds_add_u32 v50, v33 offset:1568
    s_mov_b64 exec, -1
    s_waitcnt vmcnt(2)
    s_cbranch_vccz L_th_88
    s_waitcnt vmcnt(1)
L_th_88:
    buffer_load_dwordx4 v[64:67], v40, s[60:63], s5 offen offset:0 nt
    s_waitcnt lgkmcnt(0)
    v_cmp_gt_u32 vcc, 127, v48
    v_mov_b32 v48, 127
    ds_write_b32 v49, v48 offset:1544
    ds_read_b32 v48, v50 offset:1552
    s_waitcnt lgkmcnt(0)
    v_and_b32 v20, v42, v36
    v_and_b32 v21, v42, v37
    v_and_b32 v22, v42, v38
    v_and_b32 v23, v42, v39
    ds_bpermute_b32 v35, v41, v30 offset:128
    s_nop 0
    v_mfma_f32_16x16x32_bf16 v[152:155], v[20:23], v[52:55], v[152:155]
    s_waitcnt vmcnt(2)
    s_cbranch_vccz L_th_89
    s_waitcnt vmcnt(1)
L_th_89:
    buffer_load_dwordx4 v[68:71], v40, s[60:63], s5 offen offset:128 nt
    s_waitcnt lgkmcnt(0)
    v_cmp_gt_u32 vcc, 128, v48
    v_mov_b32 v48, 128
    ds_write_b32 v49, v48 offset:1544
    ds_read_b32 v48, v50 offset:1552
    v_mfma_f32_16x16x32_bf16 v[148:151], v[20:23], v[56:59], v[148:151]
    s_waitcnt vmcnt(2)
    s_cbranch_vccz L_th_90
    s_waitcnt vmcnt(1)
L_th_90:
    buffer_load_dwordx4 v[72:75], v40, s[60:63], s5 offen offset:256 nt
    s_add_u32 s5, s5, 393216
    s_cmp_ge_u32 s5, s6
    s_cselect_b32 s5, s4, s5
    s_waitcnt lgkmcnt(0)
    v_cmp_gt_u32 vcc, 129, v48
    v_mov_b32 v48, 129
    ds_write_b32 v49, v48 offset:1544
    ds_read_b32 v48, v50 offset:1552
    v_mfma_f32_16x16x32_bf16 v[144:147], v[20:23], v[60:63], v[144:147]
    s_waitcnt vmcnt(2)
    s_cbranch_vccz L_th_91
    s_waitcnt vmcnt(1)
L_th_91:
    buffer_load_dwordx4 v[76:79], v40, s[60:63], s5 offen offset:0 nt
    s_waitcnt lgkmcnt(0)
    v_cmp_gt_u32 vcc, 130, v48
    v_mov_b32 v48, 130
    ds_write_b32 v49, v48 offset:1544
    ds_read_b32 v48, v50 offset:1552
    s_waitcnt lgkmcnt(0)
    v_and_b32 v16, v35, v36
    v_and_b32 v17, v35, v37
    v_and_b32 v18, v35, v38
    v_and_b32 v19, v35, v39
    ds_bpermute_b32 v42, v41, v30 offset:192
    s_nop 0
    v_mfma_f32_16x16x32_bf16 v[152:155], v[16:19], v[64:67], v[152:155]
    s_waitcnt vmcnt(2)
    s_cbranch_vccz L_th_92
    s_waitcnt vmcnt(1)
L_th_92:
    buffer_load_dwordx4 v[80:83], v40, s[60:63], s5 offen offset:128 nt
    s_waitcnt lgkmcnt(0)
    v_cmp_gt_u32 vcc, 131, v48
    v_mov_b32 v48, 131
    ds_write_b32 v49, v48 offset:1544
    ds_read_b32 v48, v50 offset:1552
    v_mfma_f32_16x16x32_bf16 v[148:151], v[16:19], v[68:71], v[148:151]
    s_waitcnt vmcnt(2)
    s_cbranch_vccz L_th_93
    s_waitcnt vmcnt(1)
L_th_93:
    buffer_load_dwordx4 v[84:87], v40, s[60:63], s5 offen offset:256 nt
    s_add_u32 s5, s5, 393216
    s_cmp_ge_u32 s5, s6
    s_cselect_b32 s5, s4, s5
    s_waitcnt lgkmcnt(0)
    v_cmp_gt_u32 vcc, 132, v48
    v_mov_b32 v48, 132
    ds_write_b32 v49, v48 offset:1544
    ds_read_b32 v48, v50 offset:1552
    v_mfma_f32_16x16x32_bf16 v[144:147], v[16:19], v[72:75], v[144:147]
    s_waitcnt vmcnt(2)
    s_cbranch_vccz L_th_94
    s_waitcnt vmcnt(1)
L_th_94:
    buffer_load_dwordx4 v[88:91], v40, s[60:63], s5 offen offset:0 nt
    s_waitcnt lgkmcnt(0)
    v_cmp_gt_u32 vcc, 133, v48
    v_mov_b32 v48, 133
    ds_write_b32 v49, v48 offset:1544
    ds_read_b32 v48, v50 offset:1552
    s_waitcnt lgkmcnt(0)
    v_and_b32 v20, v42, v36
    v_and_b32 v21, v42, v37
    v_and_b32 v22, v42, v38
    v_and_b32 v23, v42, v39
    ds_bpermute_b32 v35, v41, v31 offset:0
    s_nop 0
    v_mfma_f32_16x16x32_bf16 v[152:155], v[20:23], v[76:79], v[152:155]
    s_waitcnt vmcnt(2)
    s_cbranch_vccz L_th_95
    s_waitcnt vmcnt(1)
L_th_95:
    buffer_load_dwordx4 v[92:95], v40, s[60:63], s5 offen offset:128 nt
    s_waitcnt lgkmcnt(0)
    v_cmp_gt_u32 vcc, 134, v48
    v_mov_b32 v48, 134
    ds_write_b32 v49, v48 offset:1544
    ds_read_b32 v48, v50 offset:1552
    v_mfma_f32_16x16x32_bf16 v[148:151], v[20:23], v[80:83], v[148:151]
    s_waitcnt vmcnt(2)
    s_cbranch_vccz L_th_96
    s_waitcnt vmcnt(1)
L_th_96:
    buffer_load_dwordx4 v[96:99], v40, s[60:63], s5 offen offset:256 nt
    s_add_u32 s5, s5, 393216
    s_cmp_ge_u32 s5, s6
    s_cselect_b32 s5, s4, s5
    s_waitcnt lgkmcnt(0)
    v_cmp_gt_u32 vcc, 135, v48
    v_mov_b32 v48, 135
    ds_write_b32 v49, v48 offset:1544
    ds_read_b32 v48, v50 offset:1552
    v_mfma_f32_16x16x32_bf16 v[144:147], v[20:23], v[84:87], v[144:147]
    s_waitcnt vmcnt(2)
    s_cbranch_vccz L_th_97
    s_waitcnt vmcnt(1)
L_th_97:
    buffer_load_dwordx4 v[100:103], v40, s[60:63], s5 offen offset:0 nt
    s_waitcnt lgkmcnt(0)
    v_cmp_gt_u32 vcc, 136, v48
    v_mov_b32 v48, 136
    ds_write_b32 v49, v48 offset:1544
    ds_read_b32 v48, v50 offset:1552
    s_waitcnt lgkmcnt(0)
    v_and_b32 v16, v35, v36
    v_and_b32 v17, v35, v37
    v_and_b32 v18, v35, v38
    v_and_b32 v19, v35, v39
    ds_bpermute_b32 v42, v41, v31 offset:64
    s_nop 0
    v_mfma_f32_16x16x32_bf16 v[152:155], v[16:19], v[88:91], v[152:155]
    s_waitcnt vmcnt(2)
    s_cbranch_vccz L_th_98
    s_waitcnt vmcnt(1)
L_th_98:
    buffer_load_dwordx4 v[104:107], v40, s[60:63], s5 offen offset:128 nt
    s_waitcnt lgkmcnt(0)
    v_cmp_gt_u32 vcc, 137, v48
    v_mov_b32 v48, 137
    ds_write_b32 v49, v48 offset:1544
    ds_read_b32 v48, v50 offset:1552
    v_mfma_f32_16x16x32_bf16 v[148:151], v[16:19], v[92:95], v[148:151]
    s_waitcnt vmcnt(2)
    s_cbranch_vccz L_th_99
    s_waitcnt vmcnt(1)
L_th_99:
    buffer_load_dwordx4 v[108:111], v40, s[60:63], s5 offen offset:256 nt
    s_add_u32 s5, s5, 393216
    s_cmp_ge_u32 s5, s6
    s_cselect_b32 s5, s4, s5
    s_waitcnt lgkmcnt(0)
    v_cmp_gt_u32 vcc, 138, v48
    v_mov_b32 v48, 138
    ds_write_b32 v49, v48 offset:1544
    ds_read_b32 v48, v50 offset:1552
    v_mfma_f32_16x16x32_bf16 v[144:147], v[16:19], v[96:99], v[144:147]
    s_waitcnt vmcnt(2)
    s_cbranch_vccz L_th_100
    s_waitcnt vmcnt(1)
L_th_100:
    buffer_load_dwordx4 v[112:115], v40, s[60:63], s5 offen offset:0 nt
    s_waitcnt lgkmcnt(0)
    v_cmp_gt_u32 vcc, 139, v48
    v_mov_b32 v48, 139
    ds_write_b32 v49, v48 offset:1544
    ds_read_b32 v48, v50 offset:1552
    s_waitcnt lgkmcnt(0)
    v_and_b32 v20, v42, v36
    v_and_b32 v21, v42, v37
    v_and_b32 v22, v42, v38
    v_and_b32 v23, v42, v39
    ds_bpermute_b32 v35, v41, v31 offset:128
    s_nop 0
    v_mfma_f32_16x16x32_bf16 v[152:155], v[20:23], v[100:103], v[152:155]
    s_waitcnt vmcnt(2)
    s_cbranch_vccz L_th_101
    s_waitcnt vmcnt(1)
L_th_101:
    buffer_load_dwordx4 v[116:119], v40, s[60:63], s5 offen offset:128 nt
    s_waitcnt lgkmcnt(0)
    v_cmp_gt_u32 vcc, 140, v48
    v_mov_b32 v48, 140
    ds_write_b32 v49, v48 offset:1544
    ds_read_b32 v48, v50 offset:1552
    v_mfma_f32_16x16x32_bf16 v[148:151], v[20:23], v[104:107], v[148:151]
    s_waitcnt vmcnt(2)
    s_cbranch_vccz L_th_102
    s_waitcnt vmcnt(1)
L_th_102:
    buffer_load_dwordx4 v[120:123], v40, s[60:63], s5 offen offset:256 nt
    s_add_u32 s5, s5, 393216
    s_cmp_ge_u32 s5, s6
    s_cselect_b32 s5, s4, s5
    s_waitcnt lgkmcnt(0)
    v_cmp_gt_u32 vcc, 141, v48
    v_mov_b32 v48, 141
    ds_write_b32 v49, v48 offset:1544
    ds_read_b32 v48, v50 offset:1552
    v_mfma_f32_16x16x32_bf16 v[144:147], v[20:23], v[108:111], v[144:147]
    s_waitcnt vmcnt(2)
    s_cbranch_vccz L_th_103
    s_waitcnt vmcnt(1)
L_th_103:
    buffer_load_dwordx4 v[124:127], v40, s[60:63], s5 offen offset:0 nt
    s_waitcnt lgkmcnt(0)
    v_cmp_gt_u32 vcc, 142, v48
    v_mov_b32 v48, 142
    ds_write_b32 v49, v48 offset:1544
    ds_read_b32 v48, v50 offset:1552
    s_waitcnt lgkmcnt(0)
    v_and_b32 v16, v35, v36
    v_and_b32 v17, v35, v37
    v_and_b32 v18, v35, v38
    v_and_b32 v19, v35, v39
    ds_bpermute_b32 v42, v41, v31 offset:192
    s_nop 0
    v_mfma_f32_16x16x32_bf16 v[152:155], v[16:19], v[112:115], v[152:155]
    s_waitcnt vmcnt(2)
    s_cbranch_vccz L_th_104
    s_waitcnt vmcnt(1)
L_th_104:
    buffer_load_dwordx4 v[128:131], v40, s[60:63], s5 offen offset:128 nt
    s_waitcnt lgkmcnt(0)
    v_cmp_gt_u32 vcc, 143, v48
    v_mov_b32 v48, 143
    ds_write_b32 v49, v48 offset:1544
    ds_read_b32 v48, v50 offset:1552
    v_mfma_f32_16x16x32_bf16 v[148:151], v[16:19], v[116:119], v[148:151]
    s_waitcnt vmcnt(2)
    s_cbranch_vccz L_th_105
    s_waitcnt vmcnt(1)
L_th_105:
    buffer_load_dwordx4 v[132:135], v40, s[60:63], s5 offen offset:256 nt
    s_add_u32 s5, s5, 393216
    s_cmp_ge_u32 s5, s6
    s_cselect_b32 s5, s4, s5
    s_add_u32 s4, s4, 50331648
    s_add_u32 s5, s5, 50331648
    s_add_u32 s6, s6, 50331648
    s_waitcnt lgkmcnt(0)
    v_cmp_gt_u32 vcc, 144, v48
    v_mov_b32 v48, 144
    ds_write_b32 v49, v48 offset:1544
    ds_read_b32 v48, v50 offset:1552
    v_mfma_f32_16x16x32_bf16 v[144:147], v[16:19], v[120:123], v[144:147]
    s_waitcnt vmcnt(2)
    s_cbranch_vccz L_th_106
    s_waitcnt vmcnt(1)
L_th_106:
    buffer_load_dwordx4 v[136:139], v40, s[60:63], s5 offen offset:0 nt
    s_waitcnt lgkmcnt(0)
    v_cmp_gt_u32 vcc, 145, v48
    v_mov_b32 v48, 145
    ds_write_b32 v49, v48 offset:1544
    ds_read_b32 v48, v50 offset:1552
    s_waitcnt lgkmcnt(0)
    v_and_b32 v20, v42, v36
    v_and_b32 v21, v42, v37
    v_and_b32 v22, v42, v38
    v_and_b32 v23, v42, v39
    ds_bpermute_b32 v35, v41, v24 offset:0
    s_nop 0
    v_mfma_f32_16x16x32_bf16 v[152:155], v[20:23], v[124:127], v[152:155]
    s_waitcnt vmcnt(2)
    s_cbranch_vccz L_th_107
    s_waitcnt vmcnt(1)
L_th_107:
    buffer_load_dwordx4 v[140:143], v40, s[60:63], s5 offen offset:128 nt
    s_waitcnt lgkmcnt(0)
    v_cmp_gt_u32 vcc, 146, v48
    v_mov_b32 v48, 146
    ds_write_b32 v49, v48 offset:1544
    ds_read_b32 v48, v50 offset:1552
    v_mfma_f32_16x16x32_bf16 v[148:151], v[20:23], v[128:131], v[148:151]
    s_waitcnt vmcnt(2)
    s_cbranch_vccz L_th_108
    s_waitcnt vmcnt(1)
L_th_108:
    buffer_load_dwordx4 v[156:159], v40, s[60:63], s5 offen offset:256 nt
    s_add_u32 s5, s5, 393216
    s_cmp_ge_u32 s5, s6
    s_cselect_b32 s5, s4, s5
    s_waitcnt lgkmcnt(0)
    v_cmp_gt_u32 vcc, 147, v48
    v_mov_b32 v48, 147
    ds_write_b32 v49, v48 offset:1544
    ds_read_b32 v48, v50 offset:1552
    v_mfma_f32_16x16x32_bf16 v[144:147], v[20:23], v[132:135], v[144:147]
    s_waitcnt vmcnt(2)
    s_cbranch_vccz L_th_109
    s_waitcnt vmcnt(1)
L_th_109:
    buffer_load_dwordx4 v[160:163], v40, s[60:63], s5 offen offset:0 nt
    s_waitcnt lgkmcnt(0)
    v_cmp_gt_u32 vcc, 148, v48
    v_mov_b32 v48, 148
    ds_write_b32 v49, v48 offset:1544
    ds_read_b32 v48, v50 offset:1552
    s_waitcnt lgkmcnt(0)
    v_and_b32 v16, v35, v36
    v_and_b32 v17, v35, v37
    v_and_b32 v18, v35, v38
    v_and_b32 v19, v35, v39
    ds_bpermute_b32 v42, v41, v24 offset:64
    s_nop 0
    v_mfma_f32_16x16x32_bf16 v[4:7], v[16:19], v[136:139], 0
    s_waitcnt vmcnt(2)
    s_cbranch_vccz L_th_110
    s_waitcnt vmcnt(1)
L_th_110:
    buffer_load_dwordx4 v[164:167], v40, s[60:63], s5 offen offset:128 nt
    s_waitcnt lgkmcnt(0)
    v_cmp_gt_u32 vcc, 149, v48
    v_mov_b32 v48, 149
    ds_write_b32 v49, v48 offset:1544
    ds_read_b32 v48, v50 offset:1552
    v_mfma_f32_16x16x32_bf16 v[8:11], v[16:19], v[140:143], 0
    s_waitcnt vmcnt(2)
    s_cbranch_vccz L_th_111
    s_waitcnt vmcnt(1)
L_th_111:
    buffer_load_dwordx4 v[52:55], v40, s[60:63], s5 offen offset:256 nt
    s_add_u32 s5, s5, 393216
    s_cmp_ge_u32 s5, s6
    s_cselect_b32 s5, s4, s5
    s_waitcnt lgkmcnt(0)
    v_cmp_gt_u32 vcc, 150, v48
    v_mov_b32 v48, 150
    ds_write_b32 v49, v48 offset:1544
    ds_read_b32 v48, v50 offset:1552
    v_mfma_f32_16x16x32_bf16 v[12:15], v[16:19], v[156:159], 0
    s_mov_b32 exec_lo, 0x00ff00ff
    s_mov_b32 exec_hi, 0xff00ff00
    ds_write_b128 v32, v[152:155] offset:12288
    ds_write_b128 v32, v[148:151] offset:12544
    ds_write_b128 v32, v[144:147] offset:12800
    s_mov_b64 exec, -1
    s_mov_b64 exec, 1
    v_mov_b32 v33, 1
    ds_add_u32 v50, v33 offset:1572
    s_mov_b64 exec, -1
    s_waitcnt vmcnt(2)
    s_cbranch_vccz L_th_112
    s_waitcnt vmcnt(1)
L_th_112:
    buffer_load_dwordx4 v[56:59], v40, s[60:63], s5 offen offset:0 nt
    s_waitcnt lgkmcnt(0)
    v_cmp_gt_u32 vcc, 151, v48
    v_mov_b32 v48, 151
    ds_write_b32 v49, v48 offset:1544
    ds_read_b32 v48, v50 offset:1552
    s_waitcnt lgkmcnt(0)
    v_and_b32 v20, v42, v36
    v_and_b32 v21, v42, v37
    v_and_b32 v22, v42, v38
    v_and_b32 v23, v42, v39
    ds_bpermute_b32 v35, v41, v24 offset:128
    s_nop 0
    v_mfma_f32_16x16x32_bf16 v[4:7], v[20:23], v[160:163], v[4:7]
    s_waitcnt vmcnt(2)
    s_cbranch_vccz L_th_113
    s_waitcnt vmcnt(1)
L_th_113:
    buffer_load_dwordx4 v[60:63], v40, s[60:63], s5 offen offset:128 nt
    s_waitcnt lgkmcnt(0)
    v_cmp_gt_u32 vcc, 152, v48
    v_mov_b32 v48, 152
    ds_write_b32 v49, v48 offset:1544
    ds_read_b32 v48, v50 offset:1552
    v_mfma_f32_16x16x32_bf16 v[8:11], v[20:23], v[164:167], v[8:11]
    s_waitcnt vmcnt(2)
    s_cbranch_vccz L_th_114
    s_waitcnt vmcnt(1)
L_th_114:
    buffer_load_dwordx4 v[64:67], v40, s[60:63], s5 offen offset:256 nt
    s_add_u32 s5, s5, 393216
    s_cmp_ge_u32 s5, s6
    s_cselect_b32 s5, s4, s5
    s_waitcnt lgkmcnt(0)
    v_cmp_gt_u32 vcc, 153, v48
    v_mov_b32 v48, 153
    ds_write_b32 v49, v48 offset:1544
    ds_read_b32 v48, v50 offset:1552
    v_mfma_f32_16x16x32_bf16 v[12:15], v[20:23], v[52:55], v[12:15]
    s_waitcnt vmcnt(2)
    s_cbranch_vccz L_th_115
    s_waitcnt vmcnt(1)
L_th_115:
    buffer_load_dwordx4 v[68:71], v40, s[60:63], s5 offen offset:0 nt
    s_waitcnt lgkmcnt(0)
    v_cmp_gt_u32 vcc, 154, v48
    v_mov_b32 v48, 154
    ds_write_b32 v49, v48 offset:1544
    ds_read_b32 v48, v50 offset:1552
    s_waitcnt lgkmcnt(0)
    v_and_b32 v16, v35, v36
    v_and_b32 v17, v35, v37
    v_and_b32 v18, v35, v38
    v_and_b32 v19, v35, v39
    ds_bpermute_b32 v42, v41, v24 offset:192
    s_nop 0
    v_mfma_f32_16x16x32_bf16 v[4:7], v[16:19], v[56:59], v[4:7]
    s_waitcnt vmcnt(2)
    s_cbranch_vccz L_th_116
    s_waitcnt vmcnt(1)
L_th_116:
    buffer_load_dwordx4 v[72:75], v40, s[60:63], s5 offen offset:128 nt
    s_waitcnt lgkmcnt(0)
    v_cmp_gt_u32 vcc, 155, v48
    v_mov_b32 v48, 155
    ds_write_b32 v49, v48 offset:1544
    ds_read_b32 v48, v50 offset:1552
    v_mfma_f32_16x16x32_bf16 v[8:11], v[16:19], v[60:63], v[8:11]
    s_waitcnt vmcnt(2)
    s_cbranch_vccz L_th_117
    s_waitcnt vmcnt(1)
L_th_117:
    buffer_load_dwordx4 v[76:79], v40, s[60:63], s5 offen offset:256 nt
    s_add_u32 s5, s5, 393216
    s_cmp_ge_u32 s5, s6
    s_cselect_b32 s5, s4, s5
    s_waitcnt lgkmcnt(0)
    v_cmp_gt_u32 vcc, 156, v48
    v_mov_b32 v48, 156
    ds_write_b32 v49, v48 offset:1544
    ds_read_b32 v48, v50 offset:1552
    v_mfma_f32_16x16x32_bf16 v[12:15], v[16:19], v[64:67], v[12:15]
    s_waitcnt vmcnt(2)
    s_cbranch_vccz L_th_118
    s_waitcnt vmcnt(1)
L_th_118:
    buffer_load_dwordx4 v[80:83], v40, s[60:63], s5 offen offset:0 nt
    s_waitcnt lgkmcnt(0)
    v_cmp_gt_u32 vcc, 157, v48
    v_mov_b32 v48, 157
    ds_write_b32 v49, v48 offset:1544
    ds_read_b32 v48, v50 offset:1552
    s_waitcnt lgkmcnt(0)
    v_and_b32 v20, v42, v36
    v_and_b32 v21, v42, v37
    v_and_b32 v22, v42, v38
    v_and_b32 v23, v42, v39
    ds_bpermute_b32 v35, v41, v25 offset:0
    s_nop 0
    v_mfma_f32_16x16x32_bf16 v[4:7], v[20:23], v[68:71], v[4:7]
    s_waitcnt vmcnt(2)
    s_cbranch_vccz L_th_119
    s_waitcnt vmcnt(1)
L_th_119:
    buffer_load_dwordx4 v[84:87], v40, s[60:63], s5 offen offset:128 nt
    s_waitcnt lgkmcnt(0)
    v_cmp_gt_u32 vcc, 158, v48
    v_mov_b32 v48, 158
    ds_write_b32 v49, v48 offset:1544
    ds_read_b32 v48, v50 offset:1552
    v_mfma_f32_16x16x32_bf16 v[8:11], v[20:23], v[72:75], v[8:11]
    s_waitcnt vmcnt(2)
    s_cbranch_vccz L_th_120
    s_waitcnt vmcnt(1)
L_th_120:
    buffer_load_dwordx4 v[88:91], v40, s[60:63], s5 offen offset:256 nt
    s_add_u32 s5, s5, 393216
    s_cmp_ge_u32 s5, s6
    s_cselect_b32 s5, s4, s5
    s_waitcnt lgkmcnt(0)
    v_cmp_gt_u32 vcc, 159, v48
    v_mov_b32 v48, 159
    ds_write_b32 v49, v48 offset:1544
    ds_read_b32 v48, v50 offset:1552
    v_mfma_f32_16x16x32_bf16 v[12:15], v[20:23], v[76:79], v[12:15]
    s_waitcnt vmcnt(2)
    s_cbranch_vccz L_th_121
    s_waitcnt vmcnt(1)
L_th_121:
    buffer_load_dwordx4 v[92:95], v40, s[60:63], s5 offen offset:0 nt
    s_waitcnt lgkmcnt(0)
    v_cmp_gt_u32 vcc, 160, v48
    v_mov_b32 v48, 160
    ds_write_b32 v49, v48 offset:1544
    ds_read_b32 v48, v50 offset:1552
    s_waitcnt lgkmcnt(0)
    v_and_b32 v16, v35, v36
    v_and_b32 v17, v35, v37
    v_and_b32 v18, v35, v38
    v_and_b32 v19, v35, v39
    ds_bpermute_b32 v42, v41, v25 offset:64
    s_nop 0
    v_mfma_f32_16x16x32_bf16 v[4:7], v[16:19], v[80:83], v[4:7]
    s_waitcnt vmcnt(2)
    s_cbranch_vccz L_th_122
    s_waitcnt vmcnt(1)
L_th_122:
    buffer_load_dwordx4 v[96:99], v40, s[60:63], s5 offen offset:128 nt
    s_waitcnt lgkmcnt(0)
    v_cmp_gt_u32 vcc, 161, v48
    v_mov_b32 v48, 161
    ds_write_b32 v49, v48 offset:1544
    ds_read_b32 v48, v50 offset:1552
    v_mfma_f32_16x16x32_bf16 v[8:11], v[16:19], v[84:87], v[8:11]
    s_waitcnt vmcnt(2)
    s_cbranch_vccz L_th_123
    s_waitcnt vmcnt(1)
L_th_123:
    buffer_load_dwordx4 v[100:103], v40, s[60:63], s5 offen offset:256 nt
    s_add_u32 s5, s5, 393216
    s_cmp_ge_u32 s5, s6
    s_cselect_b32 s5, s4, s5
    s_waitcnt lgkmcnt(0)
    v_cmp_gt_u32 vcc, 162, v48
    v_mov_b32 v48, 162
    ds_write_b32 v49, v48 offset:1544
    ds_read_b32 v48, v50 offset:1552
    v_mfma_f32_16x16x32_bf16 v[12:15], v[16:19], v[88:91], v[12:15]
    s_waitcnt vmcnt(2)
    s_cbranch_vccz L_th_124
    s_waitcnt vmcnt(1)
L_th_124:
    buffer_load_dwordx4 v[104:107], v40, s[60:63], s5 offen offset:0 nt
    s_waitcnt lgkmcnt(0)
    v_cmp_gt_u32 vcc, 163, v48
    v_mov_b32 v48, 163
    ds_write_b32 v49, v48 offset:1544
    ds_read_b32 v48, v50 offset:1552
    s_waitcnt lgkmcnt(0)
    v_and_b32 v20, v42, v36
    v_and_b32 v21, v42, v37
    v_and_b32 v22, v42, v38
    v_and_b32 v23, v42, v39
    ds_bpermute_b32 v35, v41, v25 offset:128
    s_nop 0
    v_mfma_f32_16x16x32_bf16 v[4:7], v[20:23], v[92:95], v[4:7]
    s_waitcnt vmcnt(2)
    s_cbranch_vccz L_th_125
    s_waitcnt vmcnt(1)
L_th_125:
    buffer_load_dwordx4 v[108:111], v40, s[60:63], s5 offen offset:128 nt
    s_waitcnt lgkmcnt(0)
    v_cmp_gt_u32 vcc, 164, v48
    v_mov_b32 v48, 164
    ds_write_b32 v49, v48 offset:1544
    ds_read_b32 v48, v50 offset:1552
    v_mfma_f32_16x16x32_bf16 v[8:11], v[20:23], v[96:99], v[8:11]
    s_waitcnt vmcnt(2)
    s_cbranch_vccz L_th_126
    s_waitcnt vmcnt(1)
L_th_126:
    buffer_load_dwordx4 v[112:115], v40, s[60:63], s5 offen offset:256 nt
    s_add_u32 s5, s5, 393216
    s_cmp_ge_u32 s5, s6
    s_cselect_b32 s5, s4, s5
    s_waitcnt lgkmcnt(0)
    v_cmp_gt_u32 vcc, 165, v48
    v_mov_b32 v48, 165
    ds_write_b32 v49, v48 offset:1544
    ds_read_b32 v48, v50 offset:1552
    v_mfma_f32_16x16x32_bf16 v[12:15], v[20:23], v[100:103], v[12:15]
    s_waitcnt vmcnt(2)
    s_cbranch_vccz L_th_127
    s_waitcnt vmcnt(1)
L_th_127:
    buffer_load_dwordx4 v[116:119], v40, s[60:63], s5 offen offset:0 nt
    s_waitcnt lgkmcnt(0)
    v_cmp_gt_u32 vcc, 166, v48
    v_mov_b32 v48, 166
    ds_write_b32 v49, v48 offset:1544
    ds_read_b32 v48, v50 offset:1552
    s_waitcnt lgkmcnt(0)
    v_and_b32 v16, v35, v36
    v_and_b32 v17, v35, v37
    v_and_b32 v18, v35, v38
    v_and_b32 v19, v35, v39
    ds_bpermute_b32 v42, v41, v25 offset:192
    s_nop 0
    v_mfma_f32_16x16x32_bf16 v[4:7], v[16:19], v[104:107], v[4:7]
    s_waitcnt vmcnt(2)
    s_cbranch_vccz L_th_128
    s_waitcnt vmcnt(1)
L_th_128:
    buffer_load_dwordx4 v[120:123], v40, s[60:63], s5 offen offset:128 nt
    s_waitcnt lgkmcnt(0)
    v_cmp_gt_u32 vcc, 167, v48
    v_mov_b32 v48, 167
    ds_write_b32 v49, v48 offset:1544
    ds_read_b32 v48, v50 offset:1552
    v_mfma_f32_16x16x32_bf16 v[8:11], v[16:19], v[108:111], v[8:11]
    s_waitcnt vmcnt(2)
    s_cbranch_vccz L_th_129
    s_waitcnt vmcnt(1)
L_th_129:
    buffer_load_dwordx4 v[124:127], v40, s[60:63], s5 offen offset:256 nt
    s_add_u32 s5, s5, 393216
    s_cmp_ge_u32 s5, s6
    s_cselect_b32 s5, s4, s5
    s_add_u32 s4, s4, 50331648
    s_add_u32 s5, s5, 50331648
    s_add_u32 s6, s6, 50331648
    s_waitcnt lgkmcnt(0)
    v_cmp_gt_u32 vcc, 168, v48
    v_mov_b32 v48, 168
    ds_write_b32 v49, v48 offset:1544
    ds_read_b32 v48, v50 offset:1552
    v_mfma_f32_16x16x32_bf16 v[12:15], v[16:19], v[112:115], v[12:15]
    s_waitcnt vmcnt(2)
    s_cbranch_vccz L_th_130
    s_waitcnt vmcnt(1)
L_th_130:
    buffer_load_dwordx4 v[128:131], v40, s[60:63], s5 offen offset:0 nt
    s_waitcnt lgkmcnt(0)
    v_cmp_gt_u32 vcc, 169, v48
    v_mov_b32 v48, 169
    ds_write_b32 v49, v48 offset:1544
    ds_read_b32 v48, v50 offset:1552
    s_waitcnt lgkmcnt(0)
    v_and_b32 v20, v42, v36
    v_and_b32 v21, v42, v37
    v_and_b32 v22, v42, v38
    v_and_b32 v23, v42, v39
    ds_bpermute_b32 v35, v41, v26 offset:0
    s_nop 0
    v_mfma_f32_16x16x32_bf16 v[4:7], v[20:23], v[116:119], v[4:7]
    s_waitcnt vmcnt(2)
    s_cbranch_vccz L_th_131
    s_waitcnt vmcnt(1)
L_th_131:
    buffer_load_dwordx4 v[132:135], v40, s[60:63], s5 offen offset:128 nt
    s_waitcnt lgkmcnt(0)
    v_cmp_gt_u32 vcc, 170, v48
    v_mov_b32 v48, 170
    ds_write_b32 v49, v48 offset:1544
    ds_read_b32 v48, v50 offset:1552
    v_mfma_f32_16x16x32_bf16 v[8:11], v[20:23], v[120:123], v[8:11]
    s_waitcnt vmcnt(2)
    s_cbranch_vccz L_th_132
    s_waitcnt vmcnt(1)
L_th_132:
    buffer_load_dwordx4 v[136:139], v40, s[60:63], s5 offen offset:256 nt
    s_add_u32 s5, s5, 393216
    s_cmp_ge_u32 s5, s6
    s_cselect_b32 s5, s4, s5
    s_waitcnt lgkmcnt(0)
    v_cmp_gt_u32 vcc, 171, v48
    v_mov_b32 v48, 171
    ds_write_b32 v49, v48 offset:1544
    ds_read_b32 v48, v50 offset:1552
    v_mfma_f32_16x16x32_bf16 v[12:15], v[20:23], v[124:127], v[12:15]
    s_waitcnt vmcnt(2)
    s_cbranch_vccz L_th_133
    s_waitcnt vmcnt(1)
L_th_133:
    buffer_load_dwordx4 v[140:143], v40, s[60:63], s5 offen offset:0 nt
    s_waitcnt lgkmcnt(0)
    v_cmp_gt_u32 vcc, 172, v48
    v_mov_b32 v48, 172
    ds_write_b32 v49, v48 offset:1544
    ds_read_b32 v48, v50 offset:1552
    s_waitcnt lgkmcnt(0)
    v_and_b32 v16, v35, v36
    v_and_b32 v17, v35, v37
    v_and_b32 v18, v35, v38
    v_and_b32 v19, v35, v39
    ds_bpermute_b32 v42, v41, v26 offset:64
    s_nop 0
    v_mfma_f32_16x16x32_bf16 v[152:155], v[16:19], v[128:131], 0
    s_waitcnt vmcnt(2)
    s_cbranch_vccz L_th_134
    s_waitcnt vmcnt(1)
L_th_134:
    buffer_load_dwordx4 v[156:159], v40, s[60:63], s5 offen offset:128 nt
    s_waitcnt lgkmcnt(0)
    v_cmp_gt_u32 vcc, 173, v48
    v_mov_b32 v48, 173
    ds_write_b32 v49, v48 offset:1544
    ds_read_b32 v48, v50 offset:1552
    v_mfma_f32_16x16x32_bf16 v[148:151], v[16:19], v[132:135], 0
    s_waitcnt vmcnt(2)
    s_cbranch_vccz L_th_135
    s_waitcnt vmcnt(1)
L_th_135:
    buffer_load_dwordx4 v[160:163], v40, s[60:63], s5 offen offset:256 nt
    s_add_u32 s5, s5, 393216
    s_cmp_ge_u32 s5, s6
    s_cselect_b32 s5, s4, s5
    s_waitcnt lgkmcnt(0)
    v_cmp_gt_u32 vcc, 174, v48
    v_mov_b32 v48, 174
    ds_write_b32 v49, v48 offset:1544
    ds_read_b32 v48, v50 offset:1552
    v_mfma_f32_16x16x32_bf16 v[144:147], v[16:19], v[136:139], 0
    s_mov_b32 exec_lo, 0x00ff00ff
    s_mov_b32 exec_hi, 0xff00ff00
    ds_write_b128 v32, v[4:7] offset:24576
    ds_write_b128 v32, v[8:11] offset:24832
    ds_write_b128 v32, v[12:15] offset:25088
    s_mov_b64 exec, -1
    s_mov_b64 exec, 1
    v_mov_b32 v33, 1
    ds_add_u32 v50, v33 offset:1576
    s_mov_b64 exec, -1
    s_waitcnt vmcnt(2)
    s_cbranch_vccz L_th_136
    s_waitcnt vmcnt(1)
L_th_136:
    buffer_load_dwordx4 v[164:167], v40, s[60:63], s5 offen offset:0 nt
    s_waitcnt lgkmcnt(0)
    v_cmp_gt_u32 vcc, 175, v48
    v_mov_b32 v48, 175
    ds_write_b32 v49, v48 offset:1544
    ds_read_b32 v48, v50 offset:1552
    s_waitcnt lgkmcnt(0)
    v_and_b32 v20, v42, v36
    v_and_b32 v21, v42, v37
    v_and_b32 v22, v42, v38
    v_and_b32 v23, v42, v39
    ds_bpermute_b32 v35, v41, v26 offset:128
    s_nop 0
    v_mfma_f32_16x16x32_bf16 v[152:155], v[20:23], v[140:143], v[152:155]
    s_waitcnt vmcnt(2)
    s_cbranch_vccz L_th_137
    s_waitcnt vmcnt(1)
L_th_137:
    buffer_load_dwordx4 v[52:55], v40, s[60:63], s5 offen offset:128 nt
    s_waitcnt lgkmcnt(0)
    v_cmp_gt_u32 vcc, 176, v48
    v_mov_b32 v48, 176
    ds_write_b32 v49, v48 offset:1544
    ds_read_b32 v48, v50 offset:1552
    v_mfma_f32_16x16x32_bf16 v[148:151], v[20:23], v[156:159], v[148:151]
    s_waitcnt vmcnt(2)
    s_cbranch_vccz L_th_138
    s_waitcnt vmcnt(1)
L_th_138:
    buffer_load_dwordx4 v[56:59], v40, s[60:63], s5 offen offset:256 nt
    s_add_u32 s5, s5, 393216
    s_cmp_ge_u32 s5, s6
    s_cselect_b32 s5, s4, s5
    s_waitcnt lgkmcnt(0)
    v_cmp_gt_u32 vcc, 177, v48
    v_mov_b32 v48, 177
    ds_write_b32 v49, v48 offset:1544
    ds_read_b32 v48, v50 offset:1552
    v_mfma_f32_16x16x32_bf16 v[144:147], v[20:23], v[160:163], v[144:147]
    s_waitcnt vmcnt(2)
    s_cbranch_vccz L_th_139
    s_waitcnt vmcnt(1)
L_th_139:
    buffer_load_dwordx4 v[60:63], v40, s[60:63], s5 offen offset:0 nt
    s_waitcnt lgkmcnt(0)
    v_cmp_gt_u32 vcc, 178, v48
    v_mov_b32 v48, 178
    ds_write_b32 v49, v48 offset:1544
    ds_read_b32 v48, v50 offset:1552
    s_waitcnt lgkmcnt(0)
    v_and_b32 v16, v35, v36
    v_and_b32 v17, v35, v37
    v_and_b32 v18, v35, v38
    v_and_b32 v19, v35, v39
    ds_bpermute_b32 v42, v41, v26 offset:192
    s_nop 0
    v_mfma_f32_16x16x32_bf16 v[152:155], v[16:19], v[164:167], v[152:155]
    s_waitcnt vmcnt(2)
    s_cbranch_vccz L_th_140
    s_waitcnt vmcnt(1)
L_th_140:
    buffer_load_dwordx4 v[64:67], v40, s[60:63], s5 offen offset:128 nt
    s_waitcnt lgkmcnt(0)
    v_cmp_gt_u32 vcc, 179, v48
    v_mov_b32 v48, 179
    ds_write_b32 v49, v48 offset:1544
    ds_read_b32 v48, v50 offset:1552
    v_mfma_f32_16x16x32_bf16 v[148:151], v[16:19], v[52:55], v[148:151]
    s_waitcnt vmcnt(2)
    s_cbranch_vccz L_th_141
    s_waitcnt vmcnt(1)
L_th_141:
    buffer_load_dwordx4 v[68:71], v40, s[60:63], s5 offen offset:256 nt
    s_add_u32 s5, s5, 393216
    s_cmp_ge_u32 s5, s6
    s_cselect_b32 s5, s4, s5
    s_waitcnt lgkmcnt(0)
    v_cmp_gt_u32 vcc, 180, v48
    v_mov_b32 v48, 180
    ds_write_b32 v49, v48 offset:1544
    ds_read_b32 v48, v50 offset:1552
    v_mfma_f32_16x16x32_bf16 v[144:147], v[16:19], v[56:59], v[144:147]
    s_waitcnt vmcnt(2)
    s_cbranch_vccz L_th_142
    s_waitcnt vmcnt(1)
L_th_142:
    buffer_load_dwordx4 v[72:75], v40, s[60:63], s5 offen offset:0 nt
    s_waitcnt lgkmcnt(0)
    v_cmp_gt_u32 vcc, 181, v48
    v_mov_b32 v48, 181
    ds_write_b32 v49, v48 offset:1544
    ds_read_b32 v48, v50 offset:1552
    s_waitcnt lgkmcnt(0)
    v_and_b32 v20, v42, v36
    v_and_b32 v21, v42, v37
    v_and_b32 v22, v42, v38
    v_and_b32 v23, v42, v39
    ds_bpermute_b32 v35, v41, v27 offset:0
    s_nop 0
    v_mfma_f32_16x16x32_bf16 v[152:155], v[20:23], v[60:63], v[152:155]
    s_waitcnt vmcnt(2)
    s_cbranch_vccz L_th_143
    s_waitcnt vmcnt(1)
L_th_143:
    buffer_load_dwordx4 v[76:79], v40, s[60:63], s5 offen offset:128 nt
    s_waitcnt lgkmcnt(0)
    v_cmp_gt_u32 vcc, 182, v48
    v_mov_b32 v48, 182
    ds_write_b32 v49, v48 offset:1544
    ds_read_b32 v48, v50 offset:1552
    v_mfma_f32_16x16x32_bf16 v[148:151], v[20:23], v[64:67], v[148:151]
    s_waitcnt vmcnt(2)
    s_cbranch_vccz L_th_144
    s_waitcnt vmcnt(1)
L_th_144:
    buffer_load_dwordx4 v[80:83], v40, s[60:63], s5 offen offset:256 nt
    s_add_u32 s5, s5, 393216
    s_cmp_ge_u32 s5, s6
    s_cselect_b32 s5, s4, s5
    s_waitcnt lgkmcnt(0)
    v_cmp_gt_u32 vcc, 183, v48
    v_mov_b32 v48, 183
    ds_write_b32 v49, v48 offset:1544
    ds_read_b32 v48, v50 offset:1552
    v_mfma_f32_16x16x32_bf16 v[144:147], v[20:23], v[68:71], v[144:147]
    s_waitcnt vmcnt(2)
    s_cbranch_vccz L_th_145
    s_waitcnt vmcnt(1)
L_th_145:
    buffer_load_dwordx4 v[84:87], v40, s[60:63], s5 offen offset:0 nt
    s_waitcnt lgkmcnt(0)
    v_cmp_gt_u32 vcc, 184, v48
    v_mov_b32 v48, 184
    ds_write_b32 v49, v48 offset:1544
    ds_read_b32 v48, v50 offset:1552
    s_waitcnt lgkmcnt(0)
    v_and_b32 v16, v35, v36
    v_and_b32 v17, v35, v37
    v_and_b32 v18, v35, v38
    v_and_b32 v19, v35, v39
    ds_bpermute_b32 v42, v41, v27 offset:64
    s_nop 0
    v_mfma_f32_16x16x32_bf16 v[152:155], v[16:19], v[72:75], v[152:155]
    s_waitcnt vmcnt(2)
    s_cbranch_vccz L_th_146
    s_waitcnt vmcnt(1)
L_th_146:
    buffer_load_dwordx4 v[88:91], v40, s[60:63], s5 offen offset:128 nt
    s_waitcnt lgkmcnt(0)
    v_cmp_gt_u32 vcc, 185, v48
    v_mov_b32 v48, 185
    ds_write_b32 v49, v48 offset:1544
    ds_read_b32 v48, v50 offset:1552
    v_mfma_f32_16x16x32_bf16 v[148:151], v[16:19], v[76:79], v[148:151]
    s_waitcnt vmcnt(2)
    s_cbranch_vccz L_th_147
    s_waitcnt vmcnt(1)
L_th_147:
    buffer_load_dwordx4 v[92:95], v40, s[60:63], s5 offen offset:256 nt
    s_add_u32 s5, s5, 393216
    s_cmp_ge_u32 s5, s6
    s_cselect_b32 s5, s4, s5
    s_waitcnt lgkmcnt(0)
    v_cmp_gt_u32 vcc, 186, v48
    v_mov_b32 v48, 186
    ds_write_b32 v49, v48 offset:1544
    ds_read_b32 v48, v50 offset:1552
    v_mfma_f32_16x16x32_bf16 v[144:147], v[16:19], v[80:83], v[144:147]
    buffer_load_dwordx4 v[96:99], v40, s[60:63], s5 offen offset:0 nt
    s_waitcnt lgkmcnt(0)
    v_cmp_gt_u32 vcc, 187, v48
    v_mov_b32 v48, 187
    ds_write_b32 v49, v48 offset:1544
    ds_read_b32 v48, v50 offset:1552
    buffer_load_dwordx4 v[100:103], v40, s[60:63], s5 offen offset:128 nt
    s_waitcnt lgkmcnt(0)
    v_cmp_gt_u32 vcc, 188, v48
    v_mov_b32 v48, 188
    ds_write_b32 v49, v48 offset:1544
    ds_read_b32 v48, v50 offset:1552
    s_waitcnt vmcnt(4)
    buffer_load_dwordx4 v[104:107], v40, s[60:63], s5 offen offset:256 nt
    s_add_u32 s5, s5, 393216
    s_cmp_ge_u32 s5, s6
    s_cselect_b32 s5, s4, s5
    s_waitcnt lgkmcnt(0)
    v_cmp_gt_u32 vcc, 189, v48
    v_mov_b32 v48, 189
    ds_write_b32 v49, v48 offset:1544
    ds_read_b32 v48, v50 offset:1552
    s_waitcnt lgkmcnt(0)
    v_and_b32 v20, v42, v36
    v_and_b32 v21, v42, v37
    v_and_b32 v22, v42, v38
    v_and_b32 v23, v42, v39
    ds_bpermute_b32 v35, v41, v27 offset:128
    s_nop 0
    v_mfma_f32_16x16x32_bf16 v[152:155], v[20:23], v[84:87], v[152:155]
    s_waitcnt vmcnt(4)
    buffer_load_dwordx4 v[108:111], v40, s[60:63], s5 offen offset:0 nt
    s_waitcnt lgkmcnt(0)
    v_cmp_gt_u32 vcc, 190, v48
    v_mov_b32 v48, 190
    ds_write_b32 v49, v48 offset:1544
    ds_read_b32 v48, v50 offset:1552
    v_mfma_f32_16x16x32_bf16 v[148:151], v[20:23], v[88:91], v[148:151]
    s_waitcnt vmcnt(4)
    buffer_load_dwordx4 v[112:115], v40, s[60:63], s5 offen offset:128 nt
    s_waitcnt lgkmcnt(0)
    v_cmp_gt_u32 vcc, 191, v48
    v_mov_b32 v48, 191
    ds_write_b32 v49, v48 offset:1544
    ds_read_b32 v48, v50 offset:1552
    v_mfma_f32_16x16x32_bf16 v[144:147], v[20:23], v[92:95], v[144:147]
    s_waitcnt vmcnt(4)
    buffer_load_dwordx4 v[116:119], v40, s[60:63], s5 offen offset:256 nt
    s_mov_b64 exec, 1
    v_mov_b32 v33, 1
    ds_add_u32 v50, v33 offset:1580
    s_mov_b64 exec, -1
    s_waitcnt lgkmcnt(0)
    v_cmp_gt_u32 vcc, 192, v48
    v_mov_b32 v48, 192
    ds_write_b32 v49, v48 offset:1544
    ds_read_b32 v48, v50 offset:1552
    s_waitcnt lgkmcnt(0)
    v_and_b32 v16, v35, v36
    v_and_b32 v17, v35, v37
    v_and_b32 v18, v35, v38
    v_and_b32 v19, v35, v39
    ds_bpermute_b32 v42, v41, v27 offset:192
    s_nop 0
    v_mfma_f32_16x16x32_bf16 v[152:155], v[16:19], v[96:99], v[152:155]
    s_waitcnt vmcnt(4)
    v_mfma_f32_16x16x32_bf16 v[148:151], v[16:19], v[100:103], v[148:151]
    s_waitcnt vmcnt(3)
    v_mfma_f32_16x16x32_bf16 v[144:147], v[16:19], v[104:107], v[144:147]
    s_waitcnt lgkmcnt(0)
    v_and_b32 v20, v42, v36
    v_and_b32 v21, v42, v37
    v_and_b32 v22, v42, v38
    v_and_b32 v23, v42, v39
    s_waitcnt vmcnt(2)
    s_nop 0
    v_mfma_f32_16x16x32_bf16 v[152:155], v[20:23], v[108:111], v[152:155]
    s_waitcnt vmcnt(1)
    v_mfma_f32_16x16x32_bf16 v[148:151], v[20:23], v[112:115], v[148:151]
    s_mov_b32 exec_lo, 0x00ff00ff
    s_mov_b32 exec_hi, 0xff00ff00
    s_nop 3
    ds_write_b128 v32, v[152:155] offset:36864
    s_mov_b64 exec, -1
    s_waitcnt vmcnt(0)
    v_mfma_f32_16x16x32_bf16 v[144:147], v[20:23], v[116:119], v[144:147]
    s_mov_b32 exec_lo, 0x00ff00ff
    s_mov_b32 exec_hi, 0xff00ff00
    ds_write_b128 v32, v[148:151] offset:37120
    s_nop 4
    ds_write_b128 v32, v[144:147] offset:37376
    s_mov_b64 exec, -1
    s_waitcnt lgkmcnt(0)
    s_barrier
    s_bitcmp1_b32 s15, 3
    s_cbranch_scc1 L_D
    s_bitcmp1_b32 s15, 1
    s_cbranch_scc1 L_C
    s_bitcmp1_b32 s15, 0
    s_cbranch_scc0 L_exit
L_B:
    s_cmp_lt_u32 s12, 4
    s_cbranch_scc0 L_exit
    v_lshrrev_b32 v2, 4, v0
    v_mul_u32_u24 v2, 1024, v2
    v_bfe_u32 v3, v0, 2, 2
    v_mul_u32_u24 v3, 128, v3
    v_add_u32 v2, v2, v3
    v_and_b32 v3, 3, v0
    v_lshl_add_u32 v2, v3, 3, v2
    v_bfe_u32 v3, v0, 3, 2
    v_xor_b32 v3, s12, v3
    v_lshl_add_u32 v2, v3, 5, v2
    v_add_u32 v2, 109568, v2
    ds_read_b64_tr_b16 v[40:41], v2 offset:0
    ds_read_b64_tr_b16 v[42:43], v2 offset:512
    ds_read_b64_tr_b16 v[44:45], v2 offset:4096
    ds_read_b64_tr_b16 v[46:47], v2 offset:4608
    ds_read_b64_tr_b16 v[48:49], v2 offset:8192
    ds_read_b64_tr_b16 v[50:51], v2 offset:8704
    ds_read_b64_tr_b16 v[52:53], v2 offset:12288
    ds_read_b64_tr_b16 v[54:55], v2 offset:12800
    ds_read_b64_tr_b16 v[56:57], v2 offset:16384
    ds_read_b64_tr_b16 v[58:59], v2 offset:16896
    ds_read_b64_tr_b16 v[60:61], v2 offset:20480
    ds_read_b64_tr_b16 v[62:63], v2 offset:20992
    v_and_b32 v3, 3, v0
    v_mul_u32_u24 v3, 832, v3
    v_and_b32 v4, 48, v0
    v_add_u32 v3, v3, v4
    v_add_u32 v3, 2816, v3
    ds_read_b128 v[88:91], v3 offset:0
    ds_read_b128 v[92:95], v3 offset:64
    ds_read_b128 v[96:99], v3 offset:128
    ds_read_b128 v[100:103], v3 offset:192
    ds_read_b128 v[104:107], v3 offset:256
    ds_read_b128 v[108:111], v3 offset:320
    v_lshlrev_b32 v4, 4, v0
    s_lshr_b32 s10, s45, 1
    s_mul_i32 s10, s10, 40
    s_and_b32 s11, s45, 1
    s_mul_i32 s11, s11, 5
    s_add_u32 s11, s11, s46
    s_lshl2_add_u32 s10, s11, s10
    s_add_u32 s10, s10, s12
    s_lshl_b32 s10, s10, 8
    s_add_u32 s10, s10, 360448
    s_sub_u32 s11, s10, 163840
    s_lshl_b32 s9, s12, 7
    s_add_u32 s9, s9, 1664
    v_lshl_add_u32 v5, v0, 3, s9
    s_waitcnt lgkmcnt(0)
    v_mfma_f32_16x16x32_bf16 v[136:139], v[88:91], v[40:43], 0
    v_mfma_f32_16x16x32_bf16 v[136:139], v[92:95], v[44:47], v[136:139]
    v_mfma_f32_16x16x32_bf16 v[136:139], v[96:99], v[48:51], v[136:139]
    v_mfma_f32_16x16x32_bf16 v[136:139], v[100:103], v[52:55], v[136:139]
    v_mfma_f32_16x16x32_bf16 v[136:139], v[104:107], v[56:59], v[136:139]
    v_mfma_f32_16x16x32_bf16 v[136:139], v[108:111], v[60:63], v[136:139]
    s_cbranch_execz L_nw_148
    v_mov_b32 v6, 0
    s_mov_b32 s13, 4194304
L_prog_149:
    s_sleep 1
    ds_read_b32 v7, v6 offset:1584
    s_sub_u32 s13, s13, 1
    s_waitcnt lgkmcnt(0)
    v_readfirstlane_b32 s4, v7
    s_nop 0
    s_cselect_b32 s4, 999, s4
    s_cmp_lt_u32 s4, 2
    s_cbranch_scc1 L_prog_149
L_nw_148:
    ds_read_b64_tr_b16 v[64:65], v2 offset:24576
    ds_read_b64_tr_b16 v[66:67], v2 offset:25088
    ds_read_b64_tr_b16 v[68:69], v2 offset:28672
    ds_read_b64_tr_b16 v[70:71], v2 offset:29184
    ds_read_b64_tr_b16 v[72:73], v2 offset:32768
    ds_read_b64_tr_b16 v[74:75], v2 offset:33280
    ds_read_b64_tr_b16 v[76:77], v2 offset:36864
    ds_read_b64_tr_b16 v[78:79], v2 offset:37376
    ds_read_b64_tr_b16 v[80:81], v2 offset:40960
    ds_read_b64_tr_b16 v[82:83], v2 offset:41472
    ds_read_b64_tr_b16 v[84:85], v2 offset:45056
    ds_read_b64_tr_b16 v[86:87], v2 offset:45568
    s_waitcnt lgkmcnt(0)
    s_cbranch_execz L_lv_150
    s_barrier
L_lv_150:
    ds_read_b128 v[112:115], v3 offset:384
    ds_read_b128 v[116:119], v3 offset:448
    ds_read_b128 v[120:123], v3 offset:512
    ds_read_b128 v[124:127], v3 offset:576
    ds_read_b128 v[128:131], v3 offset:640
    ds_read_b128 v[132:135], v3 offset:704
    s_waitcnt lgkmcnt(5)
    v_mfma_f32_16x16x32_bf16 v[136:139], v[112:115], v[64:67], v[136:139]
    s_waitcnt lgkmcnt(4)
    v_mfma_f32_16x16x32_bf16 v[136:139], v[116:119], v[68:71], v[136:139]
    s_waitcnt lgkmcnt(3)
    v_mfma_f32_16x16x32_bf16 v[136:139], v[120:123], v[72:75], v[136:139]
    s_waitcnt lgkmcnt(2)
    v_mfma_f32_16x16x32_bf16 v[136:139], v[124:127], v[76:79], v[136:139]
    s_waitcnt lgkmcnt(1)
    v_mfma_f32_16x16x32_bf16 v[136:139], v[128:131], v[80:83], v[136:139]
    s_waitcnt lgkmcnt(0)
    v_mfma_f32_16x16x32_bf16 v[136:139], v[132:135], v[84:87], v[136:139]
    s_cbranch_execz L_wB
    s_mov_b64 exec, 0xffff
    s_nop 5
    v_pk_add_f32 v[136:137], v[136:137], v[138:139]
    v_bitop3_b32 v138, v136, v137, s44 bitop3:0x96
    buffer_store_dwordx4 v[136:139], v4, s[52:55], s10 offen sc1
    buffer_store_dwordx4 v[136:139], v4, s[52:55], s11 offen
    ds_write_b64 v5, v[136:137]
    s_waitcnt lgkmcnt(0)
    s_barrier
    s_endpgm
L_service:
    v_and_b32 v1, 15, v0
    v_cmp_eq_u32 vcc, 4, v1
    v_mov_b32 v2, 999
    v_lshlrev_b32 v1, 2, v1
    v_cndmask_b32 v2, 0, v2, vcc
    ds_write_b32 v1, v2 offset:1536
    s_lshr_b32 s49, s2, 3
    s_lshr_b32 s11, s2, 6
    s_mov_b32 s14, 0
    s_mov_b32 s12, s3
    s_cmp_lt_u32 s46, 5
    s_cbranch_scc0 L_nonB_151
    s_and_b32 s9, s11, 1
    s_mul_i32 s51, s9, 5
    s_add_u32 s51, s51, s46
    s_and_b32 s9, s11, 2
    s_lshl2_add_u32 s51, s51, s9
    s_and_b32 s9, s3, 1
    s_add_u32 s51, s51, s9
    s_mov_b32 s15, 1
    s_branch L_roles_152
L_nonB_151:
    s_mul_i32 s8, s11, 3
    s_add_u32 s8, s8, s46
    s_sub_u32 s8, s8, 5
    s_mul_i32 s51, s48, 6
    s_add_u32 s51, s51, s8
    s_add_u32 s9, s8, 10
    s_and_b32 s9, s9, 14
    s_lshl_b32 s10, s9, 2
    s_add_u32 s10, s10, s48
    s_lshl_b32 s14, s10, 1
    s_and_b32 s9, s8, 1
    s_add_u32 s14, s14, s9
    s_cmp_lt_u32 s10, 10
    s_cselect_b32 s15, 8, 0
    s_cmp_lt_u32 s8, 6
    s_cselect_b32 s15, 2, s15
L_roles_152:
    s_waitcnt lgkmcnt(0)
    s_load_dword s44, s[42:43], 0
    s_mov_b32 s52, s42
    s_mov_b32 s53, s43
    s_mov_b32 s54, 2490368
    s_mov_b32 s55, 0x20000
    s_barrier
    s_cmp_eq_u32 s3, 9
    s_cbranch_scc1 L_s1
    s_cmp_eq_u32 s3, 10
    s_cbranch_scc1 L_s2
    s_cmp_eq_u32 s3, 11
    s_cbranch_scc1 L_s3
    s_lshr_b32 s4, s49, 2
    s_lshl_b32 s4, s4, 3
    s_add_u32 s4, s4, s48
    s_cmp_lt_u32 s4, 60
    s_cbranch_scc0 L_noM_153
    s_and_b32 s7, s49, 3
    s_mov_b32 s56, s34
    s_mov_b32 s57, s35
    s_mov_b32 s58, 2560
    s_mov_b32 s59, 0x20000
    s_mov_b32 s60, s36
    s_mov_b32 s61, s37
    s_mov_b32 s62, 4915200
    s_mov_b32 s63, 0x20000
    v_min_u32 v1, 39, v0
    v_cmp_lt_u32 vcc, 19, v1
    v_lshlrev_b32 v1, 4, v1
    v_mov_b32 v3, 960
    v_cndmask_b32 v3, 0, v3, vcc
    v_add_u32 v3, v3, v1
    s_mul_i32 s5, s7, 320
    buffer_load_dwordx4 v[8:11], v3, s[56:59], s5 offen
    v_lshrrev_b32 v2, 3, v0
    v_mul_u32_u24 v2, 7680, v2
    v_and_b32 v3, 7, v0
    v_lshl_add_u32 v2, v3, 4, v2
    s_mul_i32 s5, s7, 1228800
    s_lshl_b32 s6, s4, 7
    s_add_u32 s5, s5, s6
    s_mov_b32 m0, 58368
    s_nop 0
    buffer_load_dwordx4 v2, s[60:63], s5 offen nt lds
    s_add_u32 s5, s5, 61440
    s_mov_b32 m0, 59392
    s_nop 0
    buffer_load_dwordx4 v2, s[60:63], s5 offen nt lds
    s_add_u32 s5, s5, 61440
    s_mov_b32 m0, 60416
    s_nop 0
    buffer_load_dwordx4 v2, s[60:63], s5 offen nt lds
    s_add_u32 s5, s5, 61440
    s_mov_b32 m0, 61440
    s_nop 0
    buffer_load_dwordx4 v2, s[60:63], s5 offen nt lds
    s_add_u32 s5, s5, 61440
    s_mov_b32 m0, 62464
    s_nop 0
    buffer_load_dwordx4 v2, s[60:63], s5 offen nt lds
    s_add_u32 s5, s5, 61440
    s_mov_b32 m0, 63488
    s_nop 0
    buffer_load_dwordx4 v2, s[60:63], s5 offen nt lds
    s_add_u32 s5, s5, 61440
    s_mov_b32 m0, 64512
    s_nop 0
    buffer_load_dwordx4 v2, s[60:63], s5 offen nt lds
    s_add_u32 s5, s5, 61440
    s_mov_b32 m0, 65536
    s_nop 0
    buffer_load_dwordx4 v2, s[60:63], s5 offen nt lds
    s_add_u32 s5, s5, 61440
    s_mov_b32 m0, 66560
    s_nop 0
    buffer_load_dwordx4 v2, s[60:63], s5 offen nt lds
    s_add_u32 s5, s5, 61440
    s_mov_b32 m0, 67584
    s_nop 0
    buffer_load_dwordx4 v2, s[60:63], s5 offen nt lds
    s_add_u32 s5, s5, 61440
    s_mov_b32 m0, 68608
    s_nop 0
    buffer_load_dwordx4 v2, s[60:63], s5 offen nt lds
    s_add_u32 s5, s5, 61440
    s_mov_b32 m0, 69632
    s_nop 0
    buffer_load_dwordx4 v2, s[60:63], s5 offen nt lds
    s_add_u32 s5, s5, 61440
    s_mov_b32 m0, 70656
    s_nop 0
    buffer_load_dwordx4 v2, s[60:63], s5 offen nt lds
    s_add_u32 s5, s5, 61440
    s_mov_b32 m0, 71680
    s_nop 0
    buffer_load_dwordx4 v2, s[60:63], s5 offen nt lds
    s_add_u32 s5, s5, 61440
    s_mov_b32 m0, 72704
    s_nop 0
    buffer_load_dwordx4 v2, s[60:63], s5 offen nt lds
    s_add_u32 s5, s5, 61440
    s_mov_b32 m0, 73728
    s_nop 0
    buffer_load_dwordx4 v2, s[60:63], s5 offen nt lds
    s_add_u32 s5, s5, 61440
    s_mov_b32 m0, 74752
    s_nop 0
    buffer_load_dwordx4 v2, s[60:63], s5 offen nt lds
    s_add_u32 s5, s5, 61440
    s_mov_b32 m0, 75776
    s_nop 0
    buffer_load_dwordx4 v2, s[60:63], s5 offen nt lds
    s_add_u32 s5, s5, 61440
    s_mov_b32 m0, 76800
    s_nop 0
    buffer_load_dwordx4 v2, s[60:63], s5 offen nt lds
    s_add_u32 s5, s5, 61440
    s_mov_b32 m0, 77824
    s_nop 0
    buffer_load_dwordx4 v2, s[60:63], s5 offen nt lds
    v_mov_b32 v4, 1564
    v_mov_b32 v5, 1
    ds_write_b32 v4, v5
    s_waitcnt vmcnt(20)
    s_mov_b32 s6, 0xbfb8aa3b
    v_lshlrev_b32 v20, 16, v8
    v_and_b32 v21, 0xffff0000, v8
    v_lshlrev_b32 v22, 16, v9
    v_and_b32 v23, 0xffff0000, v9
    v_lshlrev_b32 v24, 16, v10
    v_and_b32 v25, 0xffff0000, v10
    v_lshlrev_b32 v26, 16, v11
    v_and_b32 v27, 0xffff0000, v11
    v_mul_f32 v40, s6, v20
    v_mul_f32 v41, s6, v21
    v_mul_f32 v42, s6, v22
    v_mul_f32 v43, s6, v23
    v_mul_f32 v44, s6, v24
    v_mul_f32 v45, s6, v25
    v_mul_f32 v46, s6, v26
    v_mul_f32 v47, s6, v27
    v_exp_f32 v40, v40
    v_exp_f32 v41, v41
    v_exp_f32 v42, v42
    v_exp_f32 v43, v43
    v_exp_f32 v44, v44
    v_exp_f32 v45, v45
    v_exp_f32 v46, v46
    v_exp_f32 v47, v47
    v_add_f32 v40, 1.0, v40
    v_add_f32 v41, 1.0, v41
    v_add_f32 v42, 1.0, v42
    v_add_f32 v43, 1.0, v43
    v_add_f32 v44, 1.0, v44
    v_add_f32 v45, 1.0, v45
    v_add_f32 v46, 1.0, v46
    v_add_f32 v47, 1.0, v47
    v_min_f32 v40, 0x7f000000, v40
    v_min_f32 v41, 0x7f000000, v41
    v_min_f32 v42, 0x7f000000, v42
    v_min_f32 v43, 0x7f000000, v43
    v_min_f32 v44, 0x7f000000, v44
    v_min_f32 v45, 0x7f000000, v45
    v_min_f32 v46, 0x7f000000, v46
    v_min_f32 v47, 0x7f000000, v47
    v_rcp_f32 v48, v40
    v_rcp_f32 v49, v41
    v_rcp_f32 v50, v42
    v_rcp_f32 v51, v43
    v_rcp_f32 v52, v44
    v_rcp_f32 v53, v45
    v_rcp_f32 v54, v46
    v_rcp_f32 v55, v47
    v_mul_f32 v56, v20, v48
    v_mul_f32 v57, v21, v49
    v_mul_f32 v58, v22, v50
    v_mul_f32 v59, v23, v51
    v_mul_f32 v60, v24, v52
    v_mul_f32 v61, v25, v53
    v_mul_f32 v62, v26, v54
    v_mul_f32 v63, v27, v55
    v_fma_f32 v20, -v56, v40, v20
    v_fma_f32 v21, -v57, v41, v21
    v_fma_f32 v22, -v58, v42, v22
    v_fma_f32 v23, -v59, v43, v23
    v_fma_f32 v24, -v60, v44, v24
    v_fma_f32 v25, -v61, v45, v25
    v_fma_f32 v26, -v62, v46, v26
    v_fma_f32 v27, -v63, v47, v27
    v_fma_f32 v20, v20, v48, v56
    v_fma_f32 v21, v21, v49, v57
    v_fma_f32 v22, v22, v50, v58
    v_fma_f32 v23, v23, v51, v59
    v_fma_f32 v24, v24, v52, v60
    v_fma_f32 v25, v25, v53, v61
    v_fma_f32 v26, v26, v54, v62
    v_fma_f32 v27, v27, v55, v63
    v_cvt_pk_bf16_f32 v8, v20, v21
    v_cvt_pk_bf16_f32 v9, v22, v23
    v_cvt_pk_bf16_f32 v10, v24, v25
    v_cvt_pk_bf16_f32 v11, v26, v27
    ds_write_b128 v1, v[8:11] offset:1664
    v_and_b32 v4, 1, v0
    v_mul_u32_u24 v4, 320, v4
    v_lshrrev_b32 v5, 4, v0
    v_mul_u32_u24 v5, 16, v5
    v_add_u32 v4, v4, v5
    v_add_u32 v4, 1664, v4
    v_lshrrev_b32 v5, 4, v0
    v_mul_u32_u24 v5, 1024, v5
    v_bfe_u32 v6, v0, 2, 2
    v_mul_u32_u24 v6, 128, v6
    v_add_u32 v5, v5, v6
    v_and_b32 v6, 3, v0
    v_lshl_add_u32 v5, v6, 3, v5
    v_add_u32 v5, 58368, v5
    s_waitcnt lgkmcnt(0)
    s_add_u32 s44, s44, 0x9e3779b1
    ds_read_b128 v[12:15], v4 offset:0
    ds_read_b128 v[16:19], v4 offset:64
    ds_read_b128 v[20:23], v4 offset:128
    ds_read_b128 v[24:27], v4 offset:192
    ds_read_b128 v[28:31], v4 offset:256
    s_cmp_eq_u32 s49, 0
    s_cbranch_scc0 L_ini_156
    s_lshl_b32 s5, s48, 7
    s_add_u32 s5, s5, 2048
    s_add_u32 s6, s44, 999
    v_and_b32 v1, 31, v0
    v_lshlrev_b32 v1, 2, v1
    v_mov_b32 v6, s6
    buffer_store_dword v6, v1, s[52:55], s5 offen
L_ini_156:
    v_lshlrev_b32 v1, 4, v0
    s_mul_i32 s5, s7, 61440
    s_lshl_b32 s6, s4, 10
    s_add_u32 s5, s5, s6
    s_add_u32 s5, s5, 1703936
    v_lshrrev_b32 v2, 4, v0
    v_mul_u32_u24 v2, 61440, v2
    v_and_b32 v3, 15, v0
    v_lshl_add_u32 v2, v3, 4, v2
    s_lshl_b32 s4, s4, 2
    s_add_u32 s4, s4, s7
    s_lshl_b32 s6, s4, 8
    s_add_u32 s6, s6, 1703936
    s_waitcnt vmcnt(0)
    ds_read_b64_tr_b16 v[48:49], v5 offset:0
    ds_read_b64_tr_b16 v[50:51], v5 offset:512
    ds_read_b64_tr_b16 v[52:53], v5 offset:32
    ds_read_b64_tr_b16 v[54:55], v5 offset:544
    ds_read_b64_tr_b16 v[56:57], v5 offset:64
    ds_read_b64_tr_b16 v[58:59], v5 offset:576
    ds_read_b64_tr_b16 v[60:61], v5 offset:96
    ds_read_b64_tr_b16 v[62:63], v5 offset:608
    ds_read_b64_tr_b16 v[64:65], v5 offset:4096
    ds_read_b64_tr_b16 v[66:67], v5 offset:4608
    ds_read_b64_tr_b16 v[68:69], v5 offset:4128
    ds_read_b64_tr_b16 v[70:71], v5 offset:4640
    ds_read_b64_tr_b16 v[72:73], v5 offset:4160
    ds_read_b64_tr_b16 v[74:75], v5 offset:4672
    ds_read_b64_tr_b16 v[76:77], v5 offset:4192
    ds_read_b64_tr_b16 v[78:79], v5 offset:4704
    s_waitcnt lgkmcnt(8)
    v_mfma_f32_16x16x32_bf16 v[32:35], v[12:15], v[48:51], 0
    v_mfma_f32_16x16x32_bf16 v[36:39], v[12:15], v[52:55], 0
    v_mfma_f32_16x16x32_bf16 v[40:43], v[12:15], v[56:59], 0
    v_mfma_f32_16x16x32_bf16 v[44:47], v[12:15], v[60:63], 0
    ds_read_b64_tr_b16 v[80:81], v5 offset:8192
    ds_read_b64_tr_b16 v[82:83], v5 offset:8704
    ds_read_b64_tr_b16 v[84:85], v5 offset:8224
    ds_read_b64_tr_b16 v[86:87], v5 offset:8736
    ds_read_b64_tr_b16 v[88:89], v5 offset:8256
    ds_read_b64_tr_b16 v[90:91], v5 offset:8768
    ds_read_b64_tr_b16 v[92:93], v5 offset:8288
    ds_read_b64_tr_b16 v[94:95], v5 offset:8800
    s_waitcnt lgkmcnt(8)
    v_mfma_f32_16x16x32_bf16 v[32:35], v[16:19], v[64:67], v[32:35]
    v_mfma_f32_16x16x32_bf16 v[36:39], v[16:19], v[68:71], v[36:39]
    v_mfma_f32_16x16x32_bf16 v[40:43], v[16:19], v[72:75], v[40:43]
    v_mfma_f32_16x16x32_bf16 v[44:47], v[16:19], v[76:79], v[44:47]
    ds_read_b64_tr_b16 v[96:97], v5 offset:12288
    ds_read_b64_tr_b16 v[98:99], v5 offset:12800
    ds_read_b64_tr_b16 v[100:101], v5 offset:12320
    ds_read_b64_tr_b16 v[102:103], v5 offset:12832
    ds_read_b64_tr_b16 v[104:105], v5 offset:12352
    ds_read_b64_tr_b16 v[106:107], v5 offset:12864
    ds_read_b64_tr_b16 v[108:109], v5 offset:12384
    ds_read_b64_tr_b16 v[110:111], v5 offset:12896
    s_waitcnt lgkmcnt(8)
    v_mfma_f32_16x16x32_bf16 v[32:35], v[20:23], v[80:83], v[32:35]
    v_mfma_f32_16x16x32_bf16 v[36:39], v[20:23], v[84:87], v[36:39]
    v_mfma_f32_16x16x32_bf16 v[40:43], v[20:23], v[88:91], v[40:43]
    v_mfma_f32_16x16x32_bf16 v[44:47], v[20:23], v[92:95], v[44:47]
    ds_read_b64_tr_b16 v[112:113], v5 offset:16384
    ds_read_b64_tr_b16 v[114:115], v5 offset:16896
    ds_read_b64_tr_b16 v[116:117], v5 offset:16416
    ds_read_b64_tr_b16 v[118:119], v5 offset:16928
    ds_read_b64_tr_b16 v[120:121], v5 offset:16448
    ds_read_b64_tr_b16 v[122:123], v5 offset:16960
    ds_read_b64_tr_b16 v[124:125], v5 offset:16480
    ds_read_b64_tr_b16 v[126:127], v5 offset:16992
    s_waitcnt lgkmcnt(8)
    v_mfma_f32_16x16x32_bf16 v[32:35], v[24:27], v[96:99], v[32:35]
    v_mfma_f32_16x16x32_bf16 v[36:39], v[24:27], v[100:103], v[36:39]
    v_mfma_f32_16x16x32_bf16 v[40:43], v[24:27], v[104:107], v[40:43]
    v_mfma_f32_16x16x32_bf16 v[44:47], v[24:27], v[108:111], v[44:47]
    s_waitcnt lgkmcnt(0)
    v_mfma_f32_16x16x32_bf16 v[32:35], v[28:31], v[112:115], v[32:35]
    v_mfma_f32_16x16x32_bf16 v[36:39], v[28:31], v[116:119], v[36:39]
    v_mfma_f32_16x16x32_bf16 v[40:43], v[28:31], v[120:123], v[40:43]
    v_mfma_f32_16x16x32_bf16 v[44:47], v[28:31], v[124:127], v[44:47]
    s_nop 5
    v_mov_b32_dpp v32, v36 quad_perm:[0,1,2,3] row_mask:2 bank_mask:0xf
    v_mov_b32_dpp v33, v37 quad_perm:[0,1,2,3] row_mask:2 bank_mask:0xf
    s_nop 0
    v_mov_b32_dpp v32, v40 quad_perm:[0,1,2,3] row_mask:4 bank_mask:0xf
    v_mov_b32_dpp v33, v41 quad_perm:[0,1,2,3] row_mask:4 bank_mask:0xf
    s_nop 0
    v_mov_b32_dpp v32, v44 quad_perm:[0,1,2,3] row_mask:8 bank_mask:0xf
    v_mov_b32_dpp v33, v45 quad_perm:[0,1,2,3] row_mask:8 bank_mask:0xf
    v_bitop3_b32 v34, v32, v33, s44 bitop3:0x96
    s_cmp_lt_u32 s4, 80
    s_cbranch_scc0 L_M2_157
    buffer_store_dwordx4 v[32:35], v1, s[52:55], s5 offen sc1
    s_branch L_Mn_155
L_M2_157:
    s_mov_b32 s13, 33554432
L_loc_158:
    v_mov_b32 v6, 1536
    ds_read_b32 v6, v6
    s_waitcnt lgkmcnt(0)
    v_readfirstlane_b32 s50, v6
    s_nop 0
    s_sub_u32 s50, s50, 1
    s_cmp_le_u32 s50, 1
    s_cbranch_scc1 L_locok_159
    s_sleep 1
    s_sub_u32 s13, s13, 1
    s_cbranch_scc0 L_loc_158
L_locok_159:
    s_cmp_eq_u32 s50, 1
    s_cbranch_scc1 L_pl_160
    buffer_store_dwordx4 v[32:35], v1, s[52:55], s5 offen sc1
    s_branch L_st_161
L_pl_160:
    buffer_store_dwordx4 v[32:35], v1, s[52:55], s5 offen
L_st_161:
    s_barrier
    s_mov_b32 s13, 4194304
L_poll_162:
    buffer_load_dwordx3 v[4:6], v2, s[52:55], s6 offen sc1
    s_waitcnt vmcnt(0)
    v_bitop3_b32 v9, v4, v5, v6 bitop3:0x96
    v_xor_b32 v8, s44, v9
    v_cmp_ne_u32 vcc, 0, v8
    s_nop 0
    s_cbranch_vccz L_ok_163
    s_sleep 32
    s_sub_u32 s13, s13, 1
    s_cbranch_scc0 L_poll_162
L_ok_163:
    v_mov_b32 v8, v4
    s_nop 1
    v_permlane32_swap_b32 v4, v8
    v_add_f32 v4, v4, v8
    v_mov_b32 v9, v5
    s_nop 1
    v_permlane32_swap_b32 v5, v9
    v_add_f32 v5, v5, v9
    v_mov_b32 v8, v4
    s_nop 1
    v_permlane16_swap_b32 v4, v8
    v_add_f32 v4, v4, v8
    v_mov_b32 v9, v5
    s_nop 1
    v_permlane16_swap_b32 v5, v9
    v_add_f32 v5, v5, v9
    v_cvt_pk_bf16_f32 v4, v4, v5
    v_mov_b32 v5, s44
    v_lshlrev_b32 v3, 3, v0
    s_lshl_b32 s5, s4, 7
    s_add_u32 s5, s5, 4096
    s_mov_b64 exec, 0xffff
    buffer_store_dwordx2 v[4:5], v3, s[52:55], s5 offen sc1
    s_mov_b64 exec, -1
    s_branch L_Mj_154
L_noM_153:
    v_mov_b32 v4, 1564
    v_mov_b32 v5, 1
    ds_write_b32 v4, v5
    s_waitcnt lgkmcnt(0)
    s_add_u32 s44, s44, 0x9e3779b1
L_Mn_155:
    s_barrier
    v_mov_b32 v6, 1536
    ds_read_b32 v6, v6
    s_waitcnt lgkmcnt(0)
    v_readfirstlane_b32 s50, v6
    s_nop 0
    s_sub_u32 s50, s50, 1
L_Mj_154:
    v_mov_b32 v1, 0
    s_mov_b32 s13, 4194304
L_prog_167:
    s_sleep 32
    ds_read_b32 v2, v1 offset:1544
    s_sub_u32 s13, s13, 1
    s_waitcnt lgkmcnt(0)
    v_readfirstlane_b32 s4, v2
    s_nop 0
    s_cselect_b32 s4, 999, s4
    s_cmp_lt_u32 s4, 112
    s_cbranch_scc1 L_prog_167
    s_mov_b32 s5, 0
L_pair:
    v_lshlrev_b32 v2, 4, v0
    s_lshr_b32 s6, s45, 1
    s_lshl2_add_u32 s6, s6, s5
    s_lshl_b32 s4, s6, 11
    s_add_u32 s4, s4, 1572864
    s_mov_b32 s13, 4194304
L_poll_168:
    buffer_load_dwordx3 v[4:6], v2, s[52:55], s4 offen offset:0 sc1
    buffer_load_dwordx3 v[8:10], v2, s[52:55], s4 offen offset:1024 sc1
    s_waitcnt vmcnt(1)
    v_bitop3_b32 v13, v4, v5, v6 bitop3:0x96
    v_xor_b32 v12, s44, v13
    s_waitcnt vmcnt(0)
    v_bitop3_b32 v13, v8, v9, v10 bitop3:0x96
    v_bitop3_b32 v12, v13, s44, v12 bitop3:0xbe
    v_cmp_ne_u32 vcc, 0, v12
    s_nop 0
    s_cbranch_vccz L_ok_169
    s_sleep 32
    s_sub_u32 s13, s13, 1
    s_cbranch_scc0 L_poll_168
L_ok_169:
    v_max_f32 v12, v4, v8
    s_nop 1
    v_max_f32_dpp v12, v12, v12 quad_perm:[1,0,3,2] row_mask:0xf bank_mask:0xf
    s_nop 1
    v_max_f32_dpp v12, v12, v12 quad_perm:[2,3,0,1] row_mask:0xf bank_mask:0xf
    s_nop 1
    v_max_f32_dpp v12, v12, v12 row_half_mirror row_mask:0xf bank_mask:0xf
    s_nop 1
    v_max_f32_dpp v12, v12, v12 row_mirror row_mask:0xf bank_mask:0xf
    v_mov_b32 v13, v12
    s_nop 1
    v_permlane16_swap_b32 v12, v13
    v_max_f32 v12, v12, v13
    v_mov_b32 v13, v12
    s_nop 1
    v_permlane32_swap_b32 v12, v13
    v_max_f32 v12, v12, v13
    v_sub_f32 v4, v4, v12
    v_mul_f32 v4, 0x3fb8aa3b, v4
    v_exp_f32 v4, v4
    v_sub_f32 v8, v8, v12
    v_mul_f32 v8, 0x3fb8aa3b, v8
    v_exp_f32 v8, v8
    v_mul_f32 v5, v5, v4
    v_fmac_f32 v5, v9, v8
    s_nop 1
    v_add_f32_dpp v5, v5, v5 quad_perm:[1,0,3,2] row_mask:0xf bank_mask:0xf
    s_nop 1
    v_add_f32_dpp v5, v5, v5 quad_perm:[2,3,0,1] row_mask:0xf bank_mask:0xf
    s_nop 1
    v_add_f32_dpp v5, v5, v5 row_half_mirror row_mask:0xf bank_mask:0xf
    s_nop 1
    v_add_f32_dpp v5, v5, v5 row_mirror row_mask:0xf bank_mask:0xf
    v_mov_b32 v13, v5
    s_nop 1
    v_permlane16_swap_b32 v5, v13
    v_add_f32 v5, v5, v13
    v_mov_b32 v13, v5
    s_nop 1
    v_permlane32_swap_b32 v5, v13
    v_add_f32 v5, v5, v13
    v_rcp_f32 v5, v5
    s_bitcmp1_b32 s45, 0
    s_cselect_b64 vcc, -1, 0
    v_cndmask_b32 v4, v4, v8, vcc
    v_mul_f32 v4, v4, v5
    s_lshl_b32 s4, s46, 3
    v_readlane_b32 s64, v4, s4
    s_add_u32 s4, s4, 1
    v_readlane_b32 s65, v4, s4
    s_add_u32 s4, s4, 1
    v_readlane_b32 s66, v4, s4
    s_add_u32 s4, s4, 1
    v_readlane_b32 s67, v4, s4
    s_add_u32 s4, s4, 1
    v_readlane_b32 s68, v4, s4
    s_add_u32 s4, s4, 1
    v_readlane_b32 s69, v4, s4
    s_add_u32 s4, s4, 1
    v_readlane_b32 s70, v4, s4
    s_add_u32 s4, s4, 1
    v_readlane_b32 s71, v4, s4
    s_mul_i32 s4, s5, 12288
    s_add_u32 s4, s4, 9216
    v_lshl_add_u32 v1, v0, 2, s4
    s_lshl_b32 s7, s5, 2
    s_lshr_b32 s7, 0x3210, s7
    s_bfe_u32 s4, s7, 0x10001
    s_mul_i32 s4, s4, 832
    s_and_b32 s7, s7, 1
    s_mul_i32 s7, s7, 384
    s_add_u32 s4, s4, s7
    s_add_u32 s4, s4, 2816
    v_lshl_add_u32 v3, v0, 1, s4
    s_lshl_b32 s6, s6, 14
    s_add_u32 s6, s6, 524288
    s_and_b32 s4, s49, 15
    s_lshl_b32 s4, s4, 10
    s_add_u32 s4, s4, s6
    s_add_u32 s7, s6, 4096
    s_lshl_b32 s8, s5, 2
    v_mov_b32 v4, s8
    s_mov_b32 s13, 4194304
L_cnt_171:
    s_sleep 8
    ds_read_b32 v5, v4 offset:1568
    s_sub_u32 s13, s13, 1
    s_waitcnt lgkmcnt(0)
    v_readfirstlane_b32 s8, v5
    s_nop 0
    s_cselect_b32 s8, 8, s8
    s_cmp_lt_u32 s8, 8
    s_cbranch_scc1 L_cnt_171
L_T0:
    ds_read2st64_b32 v[16:17], v1 offset0:0 offset1:1
    ds_read2st64_b32 v[18:19], v1 offset0:2 offset1:3
    ds_read2st64_b32 v[20:21], v1 offset0:4 offset1:5
    ds_read2st64_b32 v[22:23], v1 offset0:6 offset1:7
    ds_read2st64_b32 v[24:25], v1 offset0:8 offset1:9
    ds_read2st64_b32 v[26:27], v1 offset0:10 offset1:11
    ds_read2st64_b32 v[28:29], v1 offset0:12 offset1:13
    ds_read2st64_b32 v[30:31], v1 offset0:14 offset1:15
    ds_read2st64_b32 v[32:33], v1 offset0:16 offset1:17
    ds_read2st64_b32 v[34:35], v1 offset0:18 offset1:19
    ds_read2st64_b32 v[36:37], v1 offset0:20 offset1:21
    ds_read2st64_b32 v[38:39], v1 offset0:22 offset1:23
    ds_read2st64_b32 v[40:41], v1 offset0:24 offset1:25
    ds_read2st64_b32 v[42:43], v1 offset0:26 offset1:27
    ds_read2st64_b32 v[44:45], v1 offset0:28 offset1:29
    ds_read2st64_b32 v[46:47], v1 offset0:30 offset1:31
    ds_read2st64_b32 v[48:49], v1 offset0:32 offset1:33
    ds_read2st64_b32 v[50:51], v1 offset0:34 offset1:35
    ds_read2st64_b32 v[52:53], v1 offset0:36 offset1:37
    ds_read2st64_b32 v[54:55], v1 offset0:38 offset1:39
    ds_read2st64_b32 v[56:57], v1 offset0:40 offset1:41
    ds_read2st64_b32 v[58:59], v1 offset0:42 offset1:43
    ds_read2st64_b32 v[60:61], v1 offset0:44 offset1:45
    ds_read2st64_b32 v[62:63], v1 offset0:46 offset1:47
    s_waitcnt lgkmcnt(15)
    v_pk_mul_f32 v[8:9], v[16:17], s[64:65] op_sel:[0,0] op_sel_hi:[1,0]
    v_pk_mul_f32 v[10:11], v[18:19], s[64:65] op_sel:[0,0] op_sel_hi:[1,0]
    v_pk_mul_f32 v[12:13], v[20:21], s[64:65] op_sel:[0,0] op_sel_hi:[1,0]
    v_pk_fma_f32 v[8:9], v[22:23], s[64:65], v[8:9] op_sel:[0,1,0] op_sel_hi:[1,1,1]
    v_pk_fma_f32 v[10:11], v[24:25], s[64:65], v[10:11] op_sel:[0,1,0] op_sel_hi:[1,1,1]
    v_pk_fma_f32 v[12:13], v[26:27], s[64:65], v[12:13] op_sel:[0,1,0] op_sel_hi:[1,1,1]
    v_pk_fma_f32 v[8:9], v[28:29], s[66:67], v[8:9] op_sel:[0,0,0] op_sel_hi:[1,0,1]
    v_pk_fma_f32 v[10:11], v[30:31], s[66:67], v[10:11] op_sel:[0,0,0] op_sel_hi:[1,0,1]
    v_pk_fma_f32 v[12:13], v[32:33], s[66:67], v[12:13] op_sel:[0,0,0] op_sel_hi:[1,0,1]
    s_waitcnt lgkmcnt(12)
    v_pk_fma_f32 v[8:9], v[34:35], s[66:67], v[8:9] op_sel:[0,1,0] op_sel_hi:[1,1,1]
    v_pk_fma_f32 v[10:11], v[36:37], s[66:67], v[10:11] op_sel:[0,1,0] op_sel_hi:[1,1,1]
    v_pk_fma_f32 v[12:13], v[38:39], s[66:67], v[12:13] op_sel:[0,1,0] op_sel_hi:[1,1,1]
    s_waitcnt lgkmcnt(9)
    v_pk_fma_f32 v[8:9], v[40:41], s[68:69], v[8:9] op_sel:[0,0,0] op_sel_hi:[1,0,1]
    v_pk_fma_f32 v[10:11], v[42:43], s[68:69], v[10:11] op_sel:[0,0,0] op_sel_hi:[1,0,1]
    v_pk_fma_f32 v[12:13], v[44:45], s[68:69], v[12:13] op_sel:[0,0,0] op_sel_hi:[1,0,1]
    s_waitcnt lgkmcnt(6)
    v_pk_fma_f32 v[8:9], v[46:47], s[68:69], v[8:9] op_sel:[0,1,0] op_sel_hi:[1,1,1]
    v_pk_fma_f32 v[10:11], v[48:49], s[68:69], v[10:11] op_sel:[0,1,0] op_sel_hi:[1,1,1]
    v_pk_fma_f32 v[12:13], v[50:51], s[68:69], v[12:13] op_sel:[0,1,0] op_sel_hi:[1,1,1]
    s_waitcnt lgkmcnt(3)
    v_pk_fma_f32 v[8:9], v[52:53], s[70:71], v[8:9] op_sel:[0,0,0] op_sel_hi:[1,0,1]
    v_pk_fma_f32 v[10:11], v[54:55], s[70:71], v[10:11] op_sel:[0,0,0] op_sel_hi:[1,0,1]
    v_pk_fma_f32 v[12:13], v[56:57], s[70:71], v[12:13] op_sel:[0,0,0] op_sel_hi:[1,0,1]
    s_waitcnt lgkmcnt(0)
    v_pk_fma_f32 v[8:9], v[58:59], s[70:71], v[8:9] op_sel:[0,1,0] op_sel_hi:[1,1,1]
    v_pk_fma_f32 v[10:11], v[60:61], s[70:71], v[10:11] op_sel:[0,1,0] op_sel_hi:[1,1,1]
    v_pk_fma_f32 v[12:13], v[62:63], s[70:71], v[12:13] op_sel:[0,1,0] op_sel_hi:[1,1,1]
    v_add_f32 v8, v8, v11
    v_add_f32 v9, v9, v12
    v_add_f32 v10, v10, v13
    v_bitop3_b32 v11, v8, v9, v10 bitop3:0x96
    v_xor_b32 v11, s44, v11
    s_cmp_eq_u32 s50, 1
    s_cbranch_scc1 L_pl_172
    buffer_store_dwordx4 v[8:11], v2, s[52:55], s4 offen sc1
    s_branch L_st_173
L_pl_172:
    buffer_store_dwordx4 v[8:11], v2, s[52:55], s4 offen
L_st_173:
    s_cmp_eq_u32 s5, 3
    s_cbranch_scc0 L_early_174
    s_bitcmp1_b32 s15, 0
    s_cbranch_scc1 L_Bg
    s_bitcmp1_b32 s15, 3
    s_cbranch_scc1 L_D
    s_bitcmp1_b32 s15, 1
    s_cbranch_scc0 L_exit
    s_barrier
    s_endpgm
L_early_174:
    s_bitcmp1_b32 s15, 0
    s_cbranch_scc0 L_next_175
    s_mul_i32 s9, s5, 24
    s_add_u32 s9, s9, 136
    s_min_u32 s9, s9, 182
    v_mov_b32 v12, 0
    s_mov_b32 s13, 4194304
L_prog_177:
    s_sleep 8
    ds_read_b32 v13, v12 offset:1544
    s_sub_u32 s13, s13, 1
    s_waitcnt lgkmcnt(0)
    v_readfirstlane_b32 s4, v13
    s_nop 0
    s_cselect_b32 s4, 999, s4
    s_cmp_lt_u32 s4, s9
    s_cbranch_scc1 L_prog_177
    s_add_u32 s8, s6, 8192
    s_add_u32 s9, s6, 12288
    s_mov_b32 s13, 4194304
L_poll_178:
    buffer_load_dwordx4 v[24:27], v2, s[52:55], s6 offen offset:0 sc1
    buffer_load_dwordx4 v[28:31], v2, s[52:55], s6 offen offset:1024 sc1
    buffer_load_dwordx4 v[32:35], v2, s[52:55], s6 offen offset:2048 sc1
    buffer_load_dwordx4 v[36:39], v2, s[52:55], s6 offen offset:3072 sc1
    buffer_load_dwordx4 v[40:43], v2, s[52:55], s7 offen offset:0 sc1
    buffer_load_dwordx4 v[44:47], v2, s[52:55], s7 offen offset:1024 sc1
    buffer_load_dwordx4 v[48:51], v2, s[52:55], s7 offen offset:2048 sc1
    buffer_load_dwordx4 v[52:55], v2, s[52:55], s7 offen offset:3072 sc1
    buffer_load_dwordx4 v[56:59], v2, s[52:55], s8 offen offset:0 sc1
    buffer_load_dwordx4 v[60:63], v2, s[52:55], s8 offen offset:1024 sc1
    buffer_load_dwordx4 v[64:67], v2, s[52:55], s8 offen offset:2048 sc1
    buffer_load_dwordx4 v[68:71], v2, s[52:55], s8 offen offset:3072 sc1
    buffer_load_dwordx4 v[72:75], v2, s[52:55], s9 offen offset:0 sc1
    buffer_load_dwordx4 v[76:79], v2, s[52:55], s9 offen offset:1024 sc1
    buffer_load_dwordx4 v[80:83], v2, s[52:55], s9 offen offset:2048 sc1
    buffer_load_dwordx4 v[84:87], v2, s[52:55], s9 offen offset:3072 sc1
    s_waitcnt vmcnt(15)
    v_bitop3_b32 v13, v24, v25, v26 bitop3:0x96
    v_xor_b32 v13, v13, v27
    v_xor_b32 v12, s44, v13
    s_waitcnt vmcnt(14)
    v_bitop3_b32 v13, v28, v29, v30 bitop3:0x96
    v_xor_b32 v13, v13, v31
    v_bitop3_b32 v12, v13, s44, v12 bitop3:0xbe
    v_pk_add_f32 v[16:17], v[24:25], v[28:29]
    v_add_f32 v18, v26, v30
    s_waitcnt vmcnt(13)
    v_bitop3_b32 v13, v32, v33, v34 bitop3:0x96
    v_xor_b32 v13, v13, v35
    v_bitop3_b32 v12, v13, s44, v12 bitop3:0xbe
    v_pk_add_f32 v[16:17], v[16:17], v[32:33]
    v_add_f32 v18, v18, v34
    s_waitcnt vmcnt(12)
    v_bitop3_b32 v13, v36, v37, v38 bitop3:0x96
    v_xor_b32 v13, v13, v39
    v_bitop3_b32 v12, v13, s44, v12 bitop3:0xbe
    v_pk_add_f32 v[16:17], v[16:17], v[36:37]
    v_add_f32 v18, v18, v38
    s_waitcnt vmcnt(11)
    v_bitop3_b32 v13, v40, v41, v42 bitop3:0x96
    v_xor_b32 v13, v13, v43
    v_bitop3_b32 v12, v13, s44, v12 bitop3:0xbe
    v_pk_add_f32 v[16:17], v[16:17], v[40:41]
    v_add_f32 v18, v18, v42
    s_waitcnt vmcnt(10)
    v_bitop3_b32 v13, v44, v45, v46 bitop3:0x96
    v_xor_b32 v13, v13, v47
    v_bitop3_b32 v12, v13, s44, v12 bitop3:0xbe
    v_pk_add_f32 v[16:17], v[16:17], v[44:45]
    v_add_f32 v18, v18, v46
    s_waitcnt vmcnt(9)
    v_bitop3_b32 v13, v48, v49, v50 bitop3:0x96
    v_xor_b32 v13, v13, v51
    v_bitop3_b32 v12, v13, s44, v12 bitop3:0xbe
    v_pk_add_f32 v[16:17], v[16:17], v[48:49]
    v_add_f32 v18, v18, v50
    s_waitcnt vmcnt(8)
    v_bitop3_b32 v13, v52, v53, v54 bitop3:0x96
    v_xor_b32 v13, v13, v55
    v_bitop3_b32 v12, v13, s44, v12 bitop3:0xbe
    v_pk_add_f32 v[16:17], v[16:17], v[52:53]
    v_add_f32 v18, v18, v54
    s_waitcnt vmcnt(7)
    v_bitop3_b32 v13, v56, v57, v58 bitop3:0x96
    v_xor_b32 v13, v13, v59
    v_bitop3_b32 v12, v13, s44, v12 bitop3:0xbe
    s_waitcnt vmcnt(6)
    v_bitop3_b32 v13, v60, v61, v62 bitop3:0x96
    v_xor_b32 v13, v13, v63
    v_bitop3_b32 v12, v13, s44, v12 bitop3:0xbe
    v_pk_add_f32 v[20:21], v[56:57], v[60:61]
    v_add_f32 v22, v58, v62
    s_waitcnt vmcnt(5)
    v_bitop3_b32 v13, v64, v65, v66 bitop3:0x96
    v_xor_b32 v13, v13, v67
    v_bitop3_b32 v12, v13, s44, v12 bitop3:0xbe
    v_pk_add_f32 v[20:21], v[20:21], v[64:65]
    v_add_f32 v22, v22, v66
    s_waitcnt vmcnt(4)
    v_bitop3_b32 v13, v68, v69, v70 bitop3:0x96
    v_xor_b32 v13, v13, v71
    v_bitop3_b32 v12, v13, s44, v12 bitop3:0xbe
    v_pk_add_f32 v[20:21], v[20:21], v[68:69]
    v_add_f32 v22, v22, v70
    s_waitcnt vmcnt(3)
    v_bitop3_b32 v13, v72, v73, v74 bitop3:0x96
    v_xor_b32 v13, v13, v75
    v_bitop3_b32 v12, v13, s44, v12 bitop3:0xbe
    v_pk_add_f32 v[20:21], v[20:21], v[72:73]
    v_add_f32 v22, v22, v74
    s_waitcnt vmcnt(2)
    v_bitop3_b32 v13, v76, v77, v78 bitop3:0x96
    v_xor_b32 v13, v13, v79
    v_bitop3_b32 v12, v13, s44, v12 bitop3:0xbe
    v_pk_add_f32 v[20:21], v[20:21], v[76:77]
    v_add_f32 v22, v22, v78
    s_waitcnt vmcnt(1)
    v_bitop3_b32 v13, v80, v81, v82 bitop3:0x96
    v_xor_b32 v13, v13, v83
    v_bitop3_b32 v12, v13, s44, v12 bitop3:0xbe
    v_pk_add_f32 v[20:21], v[20:21], v[80:81]
    v_add_f32 v22, v22, v82
    s_waitcnt vmcnt(0)
    v_bitop3_b32 v13, v84, v85, v86 bitop3:0x96
    v_xor_b32 v13, v13, v87
    v_bitop3_b32 v12, v13, s44, v12 bitop3:0xbe
    v_pk_add_f32 v[20:21], v[20:21], v[84:85]
    v_add_f32 v22, v22, v86
    v_cmp_ne_u32 vcc, 0, v12
    s_nop 0
    s_cbranch_vccz L_ok_179
    s_sleep 8
    s_sub_u32 s13, s13, 1
    s_cbranch_scc0 L_poll_178
L_ok_179:
    v_cvt_pk_bf16_f32 v16, v16, v17
    v_cvt_pk_bf16_f32 v18, v18, v18
    ds_write_b16 v3, v16 offset:0
    ds_write_b16_d16_hi v3, v16 offset:128
    ds_write_b16 v3, v18 offset:256
    v_cvt_pk_bf16_f32 v20, v20, v21
    v_cvt_pk_bf16_f32 v22, v22, v22
    ds_write_b16 v3, v20 offset:1664
    ds_write_b16_d16_hi v3, v20 offset:1792
    ds_write_b16 v3, v22 offset:1920
L_next_175:
    s_add_u32 s5, s5, 1
    s_cmp_lt_u32 s5, 3
    s_cbranch_scc1 L_pair
    s_bitcmp1_b32 s15, 0
    s_cbranch_scc1 L_fin_176
    s_bitcmp1_b32 s15, 3
    s_cbranch_scc1 L_D0
    s_endpgm
L_fin_176:
    s_add_u32 s6, s6, 16384
    s_add_u32 s7, s6, 4096
    v_lshlrev_b32 v3, 1, v0
    v_add_u32 v3, 4032, v3
    s_waitcnt lgkmcnt(0)
    s_barrier
L_Bg:
    s_mov_b32 s13, 4194304
L_poll_181:
    s_cbranch_execz L_lv_184
    buffer_load_dwordx4 v[24:27], v2, s[52:55], s6 offen offset:0 sc1
    buffer_load_dwordx4 v[28:31], v2, s[52:55], s6 offen offset:1024 sc1
    buffer_load_dwordx4 v[32:35], v2, s[52:55], s6 offen offset:2048 sc1
    buffer_load_dwordx4 v[36:39], v2, s[52:55], s6 offen offset:3072 sc1
    buffer_load_dwordx4 v[40:43], v2, s[52:55], s7 offen offset:0 sc1
    buffer_load_dwordx4 v[44:47], v2, s[52:55], s7 offen offset:1024 sc1
    buffer_load_dwordx4 v[48:51], v2, s[52:55], s7 offen offset:2048 sc1
    buffer_load_dwordx4 v[52:55], v2, s[52:55], s7 offen offset:3072 sc1
L_lv_184:
    s_waitcnt vmcnt(7)
    v_bitop3_b32 v13, v24, v25, v26 bitop3:0x96
    v_xor_b32 v13, v13, v27
    v_xor_b32 v12, s44, v13
    s_waitcnt vmcnt(6)
    v_bitop3_b32 v13, v28, v29, v30 bitop3:0x96
    v_xor_b32 v13, v13, v31
    v_bitop3_b32 v12, v13, s44, v12 bitop3:0xbe
    v_pk_add_f32 v[16:17], v[24:25], v[28:29]
    v_add_f32 v18, v26, v30
    s_waitcnt vmcnt(5)
    v_bitop3_b32 v13, v32, v33, v34 bitop3:0x96
    v_xor_b32 v13, v13, v35
    v_bitop3_b32 v12, v13, s44, v12 bitop3:0xbe
    v_pk_add_f32 v[16:17], v[16:17], v[32:33]
    v_add_f32 v18, v18, v34
    s_waitcnt vmcnt(4)
    v_bitop3_b32 v13, v36, v37, v38 bitop3:0x96
    v_xor_b32 v13, v13, v39
    v_bitop3_b32 v12, v13, s44, v12 bitop3:0xbe
    v_pk_add_f32 v[16:17], v[16:17], v[36:37]
    v_add_f32 v18, v18, v38
    s_waitcnt vmcnt(3)
    v_bitop3_b32 v13, v40, v41, v42 bitop3:0x96
    v_xor_b32 v13, v13, v43
    v_bitop3_b32 v12, v13, s44, v12 bitop3:0xbe
    v_pk_add_f32 v[16:17], v[16:17], v[40:41]
    v_add_f32 v18, v18, v42
    s_waitcnt vmcnt(2)
    v_bitop3_b32 v13, v44, v45, v46 bitop3:0x96
    v_xor_b32 v13, v13, v47
    v_bitop3_b32 v12, v13, s44, v12 bitop3:0xbe
    v_pk_add_f32 v[16:17], v[16:17], v[44:45]
    v_add_f32 v18, v18, v46
    s_waitcnt vmcnt(1)
    v_bitop3_b32 v13, v48, v49, v50 bitop3:0x96
    v_xor_b32 v13, v13, v51
    v_bitop3_b32 v12, v13, s44, v12 bitop3:0xbe
    v_pk_add_f32 v[16:17], v[16:17], v[48:49]
    v_add_f32 v18, v18, v50
    s_waitcnt vmcnt(0)
    v_bitop3_b32 v13, v52, v53, v54 bitop3:0x96
    v_xor_b32 v13, v13, v55
    v_bitop3_b32 v12, v13, s44, v12 bitop3:0xbe
    v_pk_add_f32 v[16:17], v[16:17], v[52:53]
    v_add_f32 v18, v18, v54
    v_cmp_ne_u32 vcc, 0, v12
    s_nop 0
    s_cbranch_vccz L_ok_182
    s_sub_u32 s13, s13, 1
    s_cbranch_scc0 L_poll_181
L_ok_182:
    v_cvt_pk_bf16_f32 v16, v16, v17
    v_cvt_pk_bf16_f32 v18, v18, v18
    ds_write_b16 v3, v16 offset:0
    ds_write_b16_d16_hi v3, v16 offset:128
    ds_write_b16 v3, v18 offset:256
    s_cbranch_execz L_wBg
    s_waitcnt lgkmcnt(0)
    s_barrier
    s_endpgm
L_s1:
    s_mov_b32 s56, s16
    s_mov_b32 s57, s17
    s_mov_b32 s58, 2560
    s_mov_b32 s59, 0x20000
    s_mov_b32 s60, s22
    s_mov_b32 s61, s23
    s_mov_b32 s62, 7864320
    s_mov_b32 s63, 0x20000
    v_and_b32 v1, 31, v0
    v_lshlrev_b32 v1, 3, v1
    v_lshrrev_b32 v2, 5, v0
    v_mul_u32_u24 v2, 1280, v2
    v_add_u32 v1, v1, v2
    buffer_load_dwordx2 v[10:11], v1, s[56:59], 0 offen offset:0
    buffer_load_dwordx2 v[12:13], v1, s[56:59], 0 offen offset:256
    buffer_load_dwordx2 v[14:15], v1, s[56:59], 0 offen offset:512
    buffer_load_dwordx2 v[16:17], v1, s[56:59], 0 offen offset:768
    buffer_load_dwordx2 v[18:19], v1, s[56:59], 0 offen offset:1024
    v_and_b32 v7, 15, v0
    v_lshl_add_u32 v2, v7, 1, v2
    s_mul_i32 s4, s46, 160
    buffer_load_ushort v160, v2, s[56:59], s4 offen offset:0
    buffer_load_ushort v161, v2, s[56:59], s4 offen offset:32
    buffer_load_ushort v162, v2, s[56:59], s4 offen offset:64
    buffer_load_ushort v163, v2, s[56:59], s4 offen offset:96
    buffer_load_ushort v164, v2, s[56:59], s4 offen offset:128
    v_lshrrev_b32 v3, 3, v0
    v_mul_u32_u24 v3, 12288, v3
    v_and_b32 v4, 7, v0
    v_lshl_add_u32 v3, v4, 4, v3
    s_lshr_b32 s6, s2, 7
    s_lshl3_add_u32 s6, s6, s48
    s_mul_i32 s5, s46, 983040
    s_and_b32 s7, s45, 1
    s_lshl4_add_u32 s6, s7, s6
    s_mul_i32 s6, s6, 384
    s_add_u32 s5, s5, s6
    v_mov_b32 v4, 1564
    s_mov_b32 s13, 4194304
L_lw_185:
    s_sleep 1
    ds_read_b32 v5, v4
    s_sub_u32 s13, s13, 1
    s_waitcnt lgkmcnt(0)
    v_readfirstlane_b32 s10, v5
    s_nop 0
    s_cselect_b32 s10, 1, s10
    s_cmp_eq_u32 s10, 1
    s_cbranch_scc0 L_lw_185
    s_mov_b32 m0, 78848
    s_nop 0
    buffer_load_dwordx4 v3, s[60:63], s5 offen nt lds
    s_add_u32 s5, s5, 128
    s_mov_b32 m0, 79872
    s_nop 0
    buffer_load_dwordx4 v3, s[60:63], s5 offen nt lds
    s_add_u32 s5, s5, 128
    s_mov_b32 m0, 80896
    s_nop 0
    buffer_load_dwordx4 v3, s[60:63], s5 offen nt lds
    s_add_u32 s5, s5, 98048
    s_mov_b32 m0, 81920
    s_nop 0
    buffer_load_dwordx4 v3, s[60:63], s5 offen nt lds
    s_add_u32 s5, s5, 128
    s_mov_b32 m0, 82944
    s_nop 0
    buffer_load_dwordx4 v3, s[60:63], s5 offen nt lds
    s_add_u32 s5, s5, 128
    s_mov_b32 m0, 83968
    s_nop 0
    buffer_load_dwordx4 v3, s[60:63], s5 offen nt lds
    s_add_u32 s5, s5, 98048
    s_mov_b32 m0, 84992
    s_nop 0
    buffer_load_dwordx4 v3, s[60:63], s5 offen nt lds
    s_add_u32 s5, s5, 128
    s_mov_b32 m0, 86016
    s_nop 0
    buffer_load_dwordx4 v3, s[60:63], s5 offen nt lds
    s_add_u32 s5, s5, 128
    s_mov_b32 m0, 87040
    s_nop 0
    buffer_load_dwordx4 v3, s[60:63], s5 offen nt lds
    s_add_u32 s5, s5, 98048
    s_mov_b32 m0, 88064
    s_nop 0
    buffer_load_dwordx4 v3, s[60:63], s5 offen nt lds
    s_add_u32 s5, s5, 128
    s_mov_b32 m0, 89088
    s_nop 0
    buffer_load_dwordx4 v3, s[60:63], s5 offen nt lds
    s_add_u32 s5, s5, 128
    s_mov_b32 m0, 90112
    s_nop 0
    buffer_load_dwordx4 v3, s[60:63], s5 offen nt lds
    s_add_u32 s5, s5, 98048
    s_mov_b32 m0, 91136
    s_nop 0
    buffer_load_dwordx4 v3, s[60:63], s5 offen nt lds
    s_add_u32 s5, s5, 128
    s_mov_b32 m0, 92160
    s_nop 0
    buffer_load_dwordx4 v3, s[60:63], s5 offen nt lds
    s_add_u32 s5, s5, 128
    s_mov_b32 m0, 93184
    s_nop 0
    buffer_load_dwordx4 v3, s[60:63], s5 offen nt lds
    s_add_u32 s5, s5, 98048
    s_mov_b32 m0, 94208
    s_nop 0
    buffer_load_dwordx4 v3, s[60:63], s5 offen nt lds
    s_add_u32 s5, s5, 128
    s_mov_b32 m0, 95232
    s_nop 0
    buffer_load_dwordx4 v3, s[60:63], s5 offen nt lds
    s_add_u32 s5, s5, 128
    s_mov_b32 m0, 96256
    s_nop 0
    buffer_load_dwordx4 v3, s[60:63], s5 offen nt lds
    s_add_u32 s5, s5, 98048
    s_mov_b32 m0, 97280
    s_nop 0
    buffer_load_dwordx4 v3, s[60:63], s5 offen nt lds
    s_add_u32 s5, s5, 128
    s_mov_b32 m0, 98304
    s_nop 0
    buffer_load_dwordx4 v3, s[60:63], s5 offen nt lds
    s_add_u32 s5, s5, 128
    s_mov_b32 m0, 99328
    s_nop 0
    buffer_load_dwordx4 v3, s[60:63], s5 offen nt lds
    s_add_u32 s5, s5, 98048
    s_mov_b32 m0, 100352
    s_nop 0
    buffer_load_dwordx4 v3, s[60:63], s5 offen nt lds
    s_add_u32 s5, s5, 128
    s_mov_b32 m0, 101376
    s_nop 0
    buffer_load_dwordx4 v3, s[60:63], s5 offen nt lds
    s_add_u32 s5, s5, 128
    s_mov_b32 m0, 102400
    s_nop 0
    buffer_load_dwordx4 v3, s[60:63], s5 offen nt lds
    s_add_u32 s5, s5, 98048
    s_mov_b32 m0, 103424
    s_nop 0
    buffer_load_dwordx4 v3, s[60:63], s5 offen nt lds
    s_add_u32 s5, s5, 128
    s_mov_b32 m0, 104448
    s_nop 0
    buffer_load_dwordx4 v3, s[60:63], s5 offen nt lds
    s_add_u32 s5, s5, 128
    s_mov_b32 m0, 105472
    s_nop 0
    buffer_load_dwordx4 v3, s[60:63], s5 offen nt lds
    s_add_u32 s5, s5, 98048
    s_mov_b32 m0, 106496
    s_nop 0
    buffer_load_dwordx4 v3, s[60:63], s5 offen nt lds
    s_add_u32 s5, s5, 128
    s_mov_b32 m0, 107520
    s_nop 0
    buffer_load_dwordx4 v3, s[60:63], s5 offen nt lds
    s_add_u32 s5, s5, 128
    s_mov_b32 m0, 108544
    s_nop 0
    buffer_load_dwordx4 v3, s[60:63], s5 offen nt lds
    v_mov_b32 v4, 1560
    v_mov_b32 v5, 1
    ds_write_b32 v4, v5
    s_waitcnt lgkmcnt(0)
    s_add_u32 s44, s44, 0x9e3779b1
    s_waitcnt vmcnt(30)
    v_lshlrev_b32 v20, 16, v10
    v_and_b32 v21, 0xffff0000, v10
    v_lshlrev_b32 v22, 16, v11
    v_and_b32 v23, 0xffff0000, v11
    v_lshlrev_b32 v24, 16, v12
    v_and_b32 v25, 0xffff0000, v12
    v_lshlrev_b32 v26, 16, v13
    v_and_b32 v27, 0xffff0000, v13
    v_lshlrev_b32 v28, 16, v14
    v_and_b32 v29, 0xffff0000, v14
    v_lshlrev_b32 v30, 16, v15
    v_and_b32 v31, 0xffff0000, v15
    v_lshlrev_b32 v32, 16, v16
    v_and_b32 v33, 0xffff0000, v16
    v_lshlrev_b32 v34, 16, v17
    v_and_b32 v35, 0xffff0000, v17
    v_lshlrev_b32 v36, 16, v18
    v_and_b32 v37, 0xffff0000, v18
    v_lshlrev_b32 v38, 16, v19
    v_and_b32 v39, 0xffff0000, v19
    v_add_f32 v4, v20, v21
    v_add_f32 v4, v4, v22
    v_add_f32 v4, v4, v23
    v_add_f32 v4, v4, v24
    v_add_f32 v4, v4, v25
    v_add_f32 v4, v4, v26
    v_add_f32 v4, v4, v27
    v_add_f32 v4, v4, v28
    v_add_f32 v4, v4, v29
    v_add_f32 v4, v4, v30
    v_add_f32 v4, v4, v31
    v_add_f32 v4, v4, v32
    v_add_f32 v4, v4, v33
    v_add_f32 v4, v4, v34
    v_add_f32 v4, v4, v35
    v_add_f32 v4, v4, v36
    v_add_f32 v4, v4, v37
    v_add_f32 v4, v4, v38
    v_add_f32 v4, v4, v39
    s_nop 1
    v_add_f32_dpp v4, v4, v4 quad_perm:[1,0,3,2] row_mask:0xf bank_mask:0xf
    s_nop 1
    v_add_f32_dpp v4, v4, v4 quad_perm:[2,3,0,1] row_mask:0xf bank_mask:0xf
    s_nop 1
    v_add_f32_dpp v4, v4, v4 row_half_mirror row_mask:0xf bank_mask:0xf
    s_nop 1
    v_add_f32_dpp v4, v4, v4 row_mirror row_mask:0xf bank_mask:0xf
    v_mov_b32 v5, v4
    s_nop 1
    v_permlane16_swap_b32 v4, v5
    v_add_f32 v4, v4, v5
    v_mul_f32 v4, 0x3acccccd, v4
    v_sub_f32 v20, v20, v4
    v_sub_f32 v21, v21, v4
    v_sub_f32 v22, v22, v4
    v_sub_f32 v23, v23, v4
    v_sub_f32 v24, v24, v4
    v_sub_f32 v25, v25, v4
    v_sub_f32 v26, v26, v4
    v_sub_f32 v27, v27, v4
    v_sub_f32 v28, v28, v4
    v_sub_f32 v29, v29, v4
    v_sub_f32 v30, v30, v4
    v_sub_f32 v31, v31, v4
    v_sub_f32 v32, v32, v4
    v_sub_f32 v33, v33, v4
    v_sub_f32 v34, v34, v4
    v_sub_f32 v35, v35, v4
    v_sub_f32 v36, v36, v4
    v_sub_f32 v37, v37, v4
    v_sub_f32 v38, v38, v4
    v_sub_f32 v39, v39, v4
    v_mul_f32 v5, v20, v20
    v_fmac_f32 v5, v21, v21
    v_fmac_f32 v5, v22, v22
    v_fmac_f32 v5, v23, v23
    v_fmac_f32 v5, v24, v24
    v_fmac_f32 v5, v25, v25
    v_fmac_f32 v5, v26, v26
    v_fmac_f32 v5, v27, v27
    v_fmac_f32 v5, v28, v28
    v_fmac_f32 v5, v29, v29
    v_fmac_f32 v5, v30, v30
    v_fmac_f32 v5, v31, v31
    v_fmac_f32 v5, v32, v32
    v_fmac_f32 v5, v33, v33
    v_fmac_f32 v5, v34, v34
    v_fmac_f32 v5, v35, v35
    v_fmac_f32 v5, v36, v36
    v_fmac_f32 v5, v37, v37
    v_fmac_f32 v5, v38, v38
    v_fmac_f32 v5, v39, v39
    s_nop 1
    v_add_f32_dpp v5, v5, v5 quad_perm:[1,0,3,2] row_mask:0xf bank_mask:0xf
    s_nop 1
    v_add_f32_dpp v5, v5, v5 quad_perm:[2,3,0,1] row_mask:0xf bank_mask:0xf
    s_nop 1
    v_add_f32_dpp v5, v5, v5 row_half_mirror row_mask:0xf bank_mask:0xf
    s_nop 1
    v_add_f32_dpp v5, v5, v5 row_mirror row_mask:0xf bank_mask:0xf
    v_mov_b32 v6, v5
    s_nop 1
    v_permlane16_swap_b32 v5, v6
    v_add_f32 v5, v5, v6
    v_mul_f32 v5, 0x3acccccd, v5
    v_cvt_pk_bf16_f32 v4, v4, v4
    v_and_b32 v4, 0xffff0000, v4
    v_cvt_pk_bf16_f32 v5, v5, v5
    v_and_b32 v5, 0xffff0000, v5
    v_add_f32 v5, 0x3727c5ac, v5
    v_cvt_pk_bf16_f32 v5, v5, v5
    v_and_b32 v5, 0xffff0000, v5
    v_sqrt_f32 v5, v5
    s_nop 0
    v_cvt_pk_bf16_f32 v5, v5, v5
    v_and_b32 v5, 0xffff0000, v5
    v_rcp_f32 v5, v5
    v_lshlrev_b32 v160, 16, v160
    v_sub_f32 v160, v160, v4
    v_cvt_pk_bf16_f32 v160, v160, v160
    v_and_b32 v160, 0xffff0000, v160
    v_mul_f32 v160, v160, v5
    v_cvt_pk_bf16_f32 v160, v160, v160
    v_and_b32 v160, 0xffff0000, v160
    v_lshlrev_b32 v161, 16, v161
    v_sub_f32 v161, v161, v4
    v_cvt_pk_bf16_f32 v161, v161, v161
    v_and_b32 v161, 0xffff0000, v161
    v_mul_f32 v161, v161, v5
    v_cvt_pk_bf16_f32 v161, v161, v161
    v_and_b32 v161, 0xffff0000, v161
    v_lshlrev_b32 v162, 16, v162
    v_sub_f32 v162, v162, v4
    v_cvt_pk_bf16_f32 v162, v162, v162
    v_and_b32 v162, 0xffff0000, v162
    v_mul_f32 v162, v162, v5
    v_cvt_pk_bf16_f32 v162, v162, v162
    v_and_b32 v162, 0xffff0000, v162
    v_lshlrev_b32 v163, 16, v163
    v_sub_f32 v163, v163, v4
    v_cvt_pk_bf16_f32 v163, v163, v163
    v_and_b32 v163, 0xffff0000, v163
    v_mul_f32 v163, v163, v5
    v_cvt_pk_bf16_f32 v163, v163, v163
    v_and_b32 v163, 0xffff0000, v163
    v_lshlrev_b32 v164, 16, v164
    v_sub_f32 v164, v164, v4
    v_cvt_pk_bf16_f32 v164, v164, v164
    v_and_b32 v164, 0xffff0000, v164
    v_mul_f32 v164, v164, v5
    v_cvt_pk_bf16_f32 v164, v164, v164
    v_and_b32 v164, 0xffff0000, v164
    v_lshrrev_b32 v4, 4, v0
    v_mul_u32_u24 v4, 3072, v4
    v_bfe_u32 v5, v0, 2, 2
    v_mul_u32_u24 v5, 128, v5
    v_add_u32 v4, v4, v5
    v_and_b32 v5, 3, v0
    v_lshl_add_u32 v4, v5, 3, v4
    v_add_u32 v4, 78848, v4
    v_lshrrev_b32 v5, 4, v0
    v_mul_u32_u24 v5, 512, v5
    v_bfe_u32 v6, v0, 2, 2
    v_mul_u32_u24 v6, 128, v6
    v_add_u32 v5, v5, v6
    v_and_b32 v6, 3, v0
    v_lshl_add_u32 v5, v6, 3, v5
    v_lshrrev_b32 v6, 5, v0
    v_mul_u32_u24 v6, 2048, v6
    v_add_u32 v5, v5, v6
    v_add_u32 v5, 103424, v5
    v_lshrrev_b32 v2, 4, v0
    v_mul_u32_u24 v2, 61440, v2
    v_and_b32 v6, 15, v0
    v_lshl_add_u32 v2, v6, 4, v2
    s_mul_i32 s4, s46, 1280
    s_add_u32 s4, s4, 1703936
    s_add_u32 s5, s4, 10240
    s_waitcnt vmcnt(0)
    ds_read_b64_tr_b16 v[100:101], v4 offset:0
    ds_read_b64_tr_b16 v[102:103], v4 offset:512
    ds_read_b64_tr_b16 v[104:105], v4 offset:12288
    ds_read_b64_tr_b16 v[106:107], v4 offset:12800
    ds_read_b64_tr_b16 v[108:109], v5 offset:0
    ds_read_b64_tr_b16 v[110:111], v4 offset:32
    ds_read_b64_tr_b16 v[112:113], v4 offset:544
    ds_read_b64_tr_b16 v[114:115], v4 offset:12320
    ds_read_b64_tr_b16 v[116:117], v4 offset:12832
    ds_read_b64_tr_b16 v[118:119], v5 offset:32
    ds_read_b64_tr_b16 v[120:121], v4 offset:64
    ds_read_b64_tr_b16 v[122:123], v4 offset:576
    ds_read_b64_tr_b16 v[124:125], v4 offset:12352
    ds_read_b64_tr_b16 v[126:127], v4 offset:12864
    ds_read_b64_tr_b16 v[128:129], v5 offset:64
    ds_read_b64_tr_b16 v[130:131], v4 offset:96
    ds_read_b64_tr_b16 v[132:133], v4 offset:608
    ds_read_b64_tr_b16 v[134:135], v4 offset:12384
    ds_read_b64_tr_b16 v[136:137], v4 offset:12896
    ds_read_b64_tr_b16 v[138:139], v5 offset:96
    ds_read_b64_tr_b16 v[140:141], v4 offset:1024
    ds_read_b64_tr_b16 v[142:143], v4 offset:1536
    ds_read_b64_tr_b16 v[144:145], v4 offset:13312
    ds_read_b64_tr_b16 v[146:147], v4 offset:13824
    ds_read_b64_tr_b16 v[148:149], v5 offset:1024
    ds_read_b64_tr_b16 v[150:151], v4 offset:1056
    ds_read_b64_tr_b16 v[152:153], v4 offset:1568
    ds_read_b64_tr_b16 v[154:155], v4 offset:13344
    ds_read_b64_tr_b16 v[156:157], v4 offset:13856
    ds_read_b64_tr_b16 v[158:159], v5 offset:1056
    s_mov_b32 s13, 4194304
    s_mov_b32 s8, 1023
L_gat_186:
    s_bitcmp1_b32 s8, 0
    s_cbranch_scc0 L_sk_188
    buffer_load_dwordx3 v[40:42], v2, s[52:55], s4 offen offset:0 sc1
L_sk_188:
    s_bitcmp1_b32 s8, 1
    s_cbranch_scc0 L_sk_189
    buffer_load_dwordx3 v[44:46], v2, s[52:55], s4 offen offset:256 sc1
L_sk_189:
    s_bitcmp1_b32 s8, 2
    s_cbranch_scc0 L_sk_190
    buffer_load_dwordx3 v[48:50], v2, s[52:55], s4 offen offset:512 sc1
L_sk_190:
    s_bitcmp1_b32 s8, 3
    s_cbranch_scc0 L_sk_191
    buffer_load_dwordx3 v[52:54], v2, s[52:55], s4 offen offset:768 sc1
L_sk_191:
    s_bitcmp1_b32 s8, 4
    s_cbranch_scc0 L_sk_192
    buffer_load_dwordx3 v[56:58], v2, s[52:55], s4 offen offset:1024 sc1
L_sk_192:
    s_bitcmp1_b32 s8, 5
    s_cbranch_scc0 L_sk_193
    buffer_load_dwordx3 v[60:62], v2, s[52:55], s5 offen offset:0 sc1
L_sk_193:
    s_bitcmp1_b32 s8, 6
    s_cbranch_scc0 L_sk_194
    buffer_load_dwordx3 v[64:66], v2, s[52:55], s5 offen offset:256 sc1
L_sk_194:
    s_bitcmp1_b32 s8, 7
    s_cbranch_scc0 L_sk_195
    buffer_load_dwordx3 v[68:70], v2, s[52:55], s5 offen offset:512 sc1
L_sk_195:
    s_bitcmp1_b32 s8, 8
    s_cbranch_scc0 L_sk_196
    buffer_load_dwordx3 v[72:74], v2, s[52:55], s5 offen offset:768 sc1
L_sk_196:
    s_bitcmp1_b32 s8, 9
    s_cbranch_scc0 L_sk_197
    buffer_load_dwordx3 v[76:78], v2, s[52:55], s5 offen offset:1024 sc1
L_sk_197:
    s_mov_b32 s8, 0
    s_waitcnt vmcnt(0)
    v_bitop3_b32 v13, v76, v77, v78 bitop3:0x96
    v_xor_b32 v12, s44, v13
    v_cmp_ne_u32 vcc, 0, v12
    s_nop 0
    s_cmp_lg_u64 vcc, 0
    s_addc_u32 s8, s8, s8
    v_bitop3_b32 v13, v72, v73, v74 bitop3:0x96
    v_xor_b32 v12, s44, v13
    v_cmp_ne_u32 vcc, 0, v12
    s_nop 0
    s_cmp_lg_u64 vcc, 0
    s_addc_u32 s8, s8, s8
    v_bitop3_b32 v13, v68, v69, v70 bitop3:0x96
    v_xor_b32 v12, s44, v13
    v_cmp_ne_u32 vcc, 0, v12
    s_nop 0
    s_cmp_lg_u64 vcc, 0
    s_addc_u32 s8, s8, s8
    v_bitop3_b32 v13, v64, v65, v66 bitop3:0x96
    v_xor_b32 v12, s44, v13
    v_cmp_ne_u32 vcc, 0, v12
    s_nop 0
    s_cmp_lg_u64 vcc, 0
    s_addc_u32 s8, s8, s8
    v_bitop3_b32 v13, v60, v61, v62 bitop3:0x96
    v_xor_b32 v12, s44, v13
    v_cmp_ne_u32 vcc, 0, v12
    s_nop 0
    s_cmp_lg_u64 vcc, 0
    s_addc_u32 s8, s8, s8
    v_bitop3_b32 v13, v56, v57, v58 bitop3:0x96
    v_xor_b32 v12, s44, v13
    v_cmp_ne_u32 vcc, 0, v12
    s_nop 0
    s_cmp_lg_u64 vcc, 0
    s_addc_u32 s8, s8, s8
    v_bitop3_b32 v13, v52, v53, v54 bitop3:0x96
    v_xor_b32 v12, s44, v13
    v_cmp_ne_u32 vcc, 0, v12
    s_nop 0
    s_cmp_lg_u64 vcc, 0
    s_addc_u32 s8, s8, s8
    v_bitop3_b32 v13, v48, v49, v50 bitop3:0x96
    v_xor_b32 v12, s44, v13
    v_cmp_ne_u32 vcc, 0, v12
    s_nop 0
    s_cmp_lg_u64 vcc, 0
    s_addc_u32 s8, s8, s8
    v_bitop3_b32 v13, v44, v45, v46 bitop3:0x96
    v_xor_b32 v12, s44, v13
    v_cmp_ne_u32 vcc, 0, v12
    s_nop 0
    s_cmp_lg_u64 vcc, 0
    s_addc_u32 s8, s8, s8
    v_bitop3_b32 v13, v40, v41, v42 bitop3:0x96
    v_xor_b32 v12, s44, v13
    v_cmp_ne_u32 vcc, 0, v12
    s_nop 0
    s_cmp_lg_u64 vcc, 0
    s_addc_u32 s8, s8, s8
    s_cmp_eq_u32 s8, 0
    s_cbranch_scc1 L_ok_187
    s_sleep 8
    s_sub_u32 s13, s13, 1
    s_cbranch_scc0 L_gat_186
L_ok_187:
    v_permlane32_swap_b32 v40, v41
    v_permlane32_swap_b32 v44, v45
    v_permlane32_swap_b32 v48, v49
    v_permlane32_swap_b32 v52, v53
    v_permlane32_swap_b32 v56, v57
    v_permlane32_swap_b32 v60, v61
    v_permlane32_swap_b32 v64, v65
    v_permlane32_swap_b32 v68, v69
    v_permlane32_swap_b32 v72, v73
    v_permlane32_swap_b32 v76, v77
    v_add_f32 v40, v40, v41
    v_add_f32 v44, v44, v45
    v_add_f32 v48, v48, v49
    v_add_f32 v52, v52, v53
    v_add_f32 v56, v56, v57
    v_add_f32 v60, v60, v61
    v_add_f32 v64, v64, v65
    v_add_f32 v68, v68, v69
    v_add_f32 v72, v72, v73
    v_add_f32 v76, v76, v77
    v_mov_b32 v41, v40
    v_mov_b32 v45, v44
    v_mov_b32 v49, v48
    v_mov_b32 v53, v52
    v_mov_b32 v57, v56
    v_mov_b32 v61, v60
    v_mov_b32 v65, v64
    v_mov_b32 v69, v68
    v_mov_b32 v73, v72
    v_mov_b32 v77, v76
    v_permlane16_swap_b32 v40, v41
    v_permlane16_swap_b32 v44, v45
    v_permlane16_swap_b32 v48, v49
    v_permlane16_swap_b32 v52, v53
    v_permlane16_swap_b32 v56, v57
    v_permlane16_swap_b32 v60, v61
    v_permlane16_swap_b32 v64, v65
    v_permlane16_swap_b32 v68, v69
    v_permlane16_swap_b32 v72, v73
    v_permlane16_swap_b32 v76, v77
    v_add_f32 v40, v40, v41
    v_add_f32 v44, v44, v45
    v_add_f32 v48, v48, v49
    v_add_f32 v52, v52, v53
    v_add_f32 v56, v56, v57
    v_add_f32 v60, v60, v61
    v_add_f32 v64, v64, v65
    v_add_f32 v68, v68, v69
    v_add_f32 v72, v72, v73
    v_add_f32 v76, v76, v77
    v_cvt_pk_bf16_f32 v40, v40, v40
    v_and_b32 v40, 0xffff0000, v40
    v_cvt_pk_bf16_f32 v44, v44, v44
    v_and_b32 v44, 0xffff0000, v44
    v_cvt_pk_bf16_f32 v48, v48, v48
    v_and_b32 v48, 0xffff0000, v48
    v_cvt_pk_bf16_f32 v52, v52, v52
    v_and_b32 v52, 0xffff0000, v52
    v_cvt_pk_bf16_f32 v56, v56, v56
    v_and_b32 v56, 0xffff0000, v56
    v_cvt_pk_bf16_f32 v60, v60, v60
    v_and_b32 v60, 0xffff0000, v60
    v_cvt_pk_bf16_f32 v64, v64, v64
    v_and_b32 v64, 0xffff0000, v64
    v_cvt_pk_bf16_f32 v68, v68, v68
    v_and_b32 v68, 0xffff0000, v68
    v_cvt_pk_bf16_f32 v72, v72, v72
    v_and_b32 v72, 0xffff0000, v72
    v_cvt_pk_bf16_f32 v76, v76, v76
    v_and_b32 v76, 0xffff0000, v76
    v_lshrrev_b32 v2, 5, v0
    v_mul_u32_u24 v2, 192, v2
    v_lshl_add_u32 v2, v7, 1, v2
    v_add_f32 v60, 1.0, v60
    v_cvt_pk_bf16_f32 v60, v60, v60
    v_and_b32 v60, 0xffff0000, v60
    v_mul_f32 v160, v160, v60
    v_cvt_pk_bf16_f32 v160, v160, v160
    v_and_b32 v160, 0xffff0000, v160
    v_add_f32 v160, v160, v40
    v_cvt_pk_bf16_f32 v160, v160, v160
    ds_write_b16 v2, v160 offset:2304
    v_add_f32 v64, 1.0, v64
    v_cvt_pk_bf16_f32 v64, v64, v64
    v_and_b32 v64, 0xffff0000, v64
    v_mul_f32 v161, v161, v64
    v_cvt_pk_bf16_f32 v161, v161, v161
    v_and_b32 v161, 0xffff0000, v161
    v_add_f32 v161, v161, v44
    v_cvt_pk_bf16_f32 v161, v161, v161
    ds_write_b16 v2, v161 offset:2336
    v_add_f32 v68, 1.0, v68
    v_cvt_pk_bf16_f32 v68, v68, v68
    v_and_b32 v68, 0xffff0000, v68
    v_mul_f32 v162, v162, v68
    v_cvt_pk_bf16_f32 v162, v162, v162
    v_and_b32 v162, 0xffff0000, v162
    v_add_f32 v162, v162, v48
    v_cvt_pk_bf16_f32 v162, v162, v162
    ds_write_b16 v2, v162 offset:2368
    v_add_f32 v72, 1.0, v72
    v_cvt_pk_bf16_f32 v72, v72, v72
    v_and_b32 v72, 0xffff0000, v72
    v_mul_f32 v163, v163, v72
    v_cvt_pk_bf16_f32 v163, v163, v163
    v_and_b32 v163, 0xffff0000, v163
    v_add_f32 v163, v163, v52
    v_cvt_pk_bf16_f32 v163, v163, v163
    ds_write_b16 v2, v163 offset:2400
    v_add_f32 v76, 1.0, v76
    v_cvt_pk_bf16_f32 v76, v76, v76
    v_and_b32 v76, 0xffff0000, v76
    v_mul_f32 v164, v164, v76
    v_cvt_pk_bf16_f32 v164, v164, v164
    v_and_b32 v164, 0xffff0000, v164
    v_add_f32 v164, v164, v56
    v_cvt_pk_bf16_f32 v164, v164, v164
    ds_write_b16 v2, v164 offset:2432
    s_mov_b32 s13, 33554432
L_loc_198:
    v_mov_b32 v6, 1536
    ds_read_b32 v6, v6
    s_waitcnt lgkmcnt(0)
    v_readfirstlane_b32 s50, v6
    s_nop 0
    s_sub_u32 s50, s50, 1
    s_cmp_le_u32 s50, 1
    s_cbranch_scc1 L_locok_199
    s_sleep 1
    s_sub_u32 s13, s13, 1
    s_cbranch_scc0 L_loc_198
L_locok_199:
    v_and_b32 v2, 1, v0
    v_mul_u32_u24 v2, 192, v2
    v_lshrrev_b32 v3, 4, v0
    v_mul_u32_u24 v3, 16, v3
    v_add_u32 v2, v2, v3
    v_add_u32 v2, 2304, v2
    v_and_b32 v3, 1, v0
    v_mul_u32_u24 v3, 192, v3
    v_lshrrev_b32 v6, 4, v0
    v_mul_u32_u24 v6, 8, v6
    v_add_u32 v3, v3, v6
    v_add_u32 v3, 2432, v3
    s_waitcnt lgkmcnt(0)
    ds_read_b128 v[88:91], v2
    ds_read_b128 v[92:95], v2 offset:64
    ds_read_b64 v[96:97], v3
    s_waitcnt lgkmcnt(0)
    v_mfma_f32_16x16x16_bf16 v[40:43], v[96:97], v[108:109], 0
    v_mfma_f32_16x16x16_bf16 v[44:47], v[96:97], v[118:119], 0
    v_mfma_f32_16x16x16_bf16 v[48:51], v[96:97], v[128:129], 0
    v_mfma_f32_16x16x16_bf16 v[52:55], v[96:97], v[138:139], 0
    v_mfma_f32_16x16x16_bf16 v[56:59], v[96:97], v[148:149], 0
    v_mfma_f32_16x16x16_bf16 v[60:63], v[96:97], v[158:159], 0
    s_nop 2
    v_mfma_f32_16x16x32_bf16 v[40:43], v[88:91], v[100:103], v[40:43]
    v_mfma_f32_16x16x32_bf16 v[44:47], v[88:91], v[110:113], v[44:47]
    v_mfma_f32_16x16x32_bf16 v[48:51], v[88:91], v[120:123], v[48:51]
    v_mfma_f32_16x16x32_bf16 v[52:55], v[88:91], v[130:133], v[52:55]
    v_mfma_f32_16x16x32_bf16 v[56:59], v[88:91], v[140:143], v[56:59]
    v_mfma_f32_16x16x32_bf16 v[60:63], v[88:91], v[150:153], v[60:63]
    v_mfma_f32_16x16x32_bf16 v[40:43], v[92:95], v[104:107], v[40:43]
    ds_read_b64_tr_b16 v[100:101], v4 offset:1088
    ds_read_b64_tr_b16 v[102:103], v4 offset:1600
    ds_read_b64_tr_b16 v[104:105], v4 offset:13376
    ds_read_b64_tr_b16 v[106:107], v4 offset:13888
    ds_read_b64_tr_b16 v[108:109], v5 offset:1088
    v_mfma_f32_16x16x32_bf16 v[44:47], v[92:95], v[114:117], v[44:47]
    ds_read_b64_tr_b16 v[110:111], v4 offset:1120
    ds_read_b64_tr_b16 v[112:113], v4 offset:1632
    ds_read_b64_tr_b16 v[114:115], v4 offset:13408
    ds_read_b64_tr_b16 v[116:117], v4 offset:13920
    ds_read_b64_tr_b16 v[118:119], v5 offset:1120
    v_mfma_f32_16x16x32_bf16 v[48:51], v[92:95], v[124:127], v[48:51]
    ds_read_b64_tr_b16 v[120:121], v4 offset:2048
    ds_read_b64_tr_b16 v[122:123], v4 offset:2560
    ds_read_b64_tr_b16 v[124:125], v4 offset:14336
    ds_read_b64_tr_b16 v[126:127], v4 offset:14848
    ds_read_b64_tr_b16 v[128:129], v5 offset:2048
    v_mfma_f32_16x16x32_bf16 v[52:55], v[92:95], v[134:137], v[52:55]
    ds_read_b64_tr_b16 v[130:131], v4 offset:2080
    ds_read_b64_tr_b16 v[132:133], v4 offset:2592
    ds_read_b64_tr_b16 v[134:135], v4 offset:14368
    ds_read_b64_tr_b16 v[136:137], v4 offset:14880
    ds_read_b64_tr_b16 v[138:139], v5 offset:2080
    v_mfma_f32_16x16x32_bf16 v[56:59], v[92:95], v[144:147], v[56:59]
    ds_read_b64_tr_b16 v[140:141], v4 offset:2112
    ds_read_b64_tr_b16 v[142:143], v4 offset:2624
    ds_read_b64_tr_b16 v[144:145], v4 offset:14400
    ds_read_b64_tr_b16 v[146:147], v4 offset:14912
    ds_read_b64_tr_b16 v[148:149], v5 offset:2112
    v_mfma_f32_16x16x32_bf16 v[60:63], v[92:95], v[154:157], v[60:63]
    ds_read_b64_tr_b16 v[150:151], v4 offset:2144
    ds_read_b64_tr_b16 v[152:153], v4 offset:2656
    ds_read_b64_tr_b16 v[154:155], v4 offset:14432
    ds_read_b64_tr_b16 v[156:157], v4 offset:14944
    ds_read_b64_tr_b16 v[158:159], v5 offset:2144
    s_waitcnt lgkmcnt(0)
    v_mfma_f32_16x16x16_bf16 v[64:67], v[96:97], v[108:109], 0
    v_mfma_f32_16x16x16_bf16 v[68:71], v[96:97], v[118:119], 0
    v_mfma_f32_16x16x16_bf16 v[72:75], v[96:97], v[128:129], 0
    v_mfma_f32_16x16x16_bf16 v[76:79], v[96:97], v[138:139], 0
    v_mfma_f32_16x16x16_bf16 v[80:83], v[96:97], v[148:149], 0
    v_mfma_f32_16x16x16_bf16 v[84:87], v[96:97], v[158:159], 0
    s_nop 2
    v_mfma_f32_16x16x32_bf16 v[64:67], v[88:91], v[100:103], v[64:67]
    v_mfma_f32_16x16x32_bf16 v[68:71], v[88:91], v[110:113], v[68:71]
    v_mfma_f32_16x16x32_bf16 v[72:75], v[88:91], v[120:123], v[72:75]
    v_mfma_f32_16x16x32_bf16 v[76:79], v[88:91], v[130:133], v[76:79]
    v_mfma_f32_16x16x32_bf16 v[80:83], v[88:91], v[140:143], v[80:83]
    v_mfma_f32_16x16x32_bf16 v[84:87], v[88:91], v[150:153], v[84:87]
    v_mfma_f32_16x16x32_bf16 v[64:67], v[92:95], v[104:107], v[64:67]
    v_mfma_f32_16x16x32_bf16 v[68:71], v[92:95], v[114:117], v[68:71]
    v_mfma_f32_16x16x32_bf16 v[72:75], v[92:95], v[124:127], v[72:75]
    v_mfma_f32_16x16x32_bf16 v[76:79], v[92:95], v[134:137], v[76:79]
    v_mfma_f32_16x16x32_bf16 v[80:83], v[92:95], v[144:147], v[80:83]
    v_mfma_f32_16x16x32_bf16 v[84:87], v[92:95], v[154:157], v[84:87]
    v_lshlrev_b32 v2, 4, v0
    s_lshl_b32 s4, s45, 3
    s_add_u32 s5, s4, s46
    s_lshl_b32 s5, s5, 11
    s_add_u32 s5, s5, 1966080
    v_mov_b32_dpp v16, v40 quad_perm:[0,1,2,3] row_mask:1 bank_mask:0xf
    v_mov_b32_dpp v17, v44 quad_perm:[0,1,2,3] row_mask:1 bank_mask:0xf
    v_mov_b32_dpp v18, v48 quad_perm:[0,1,2,3] row_mask:1 bank_mask:0xf
    v_mov_b32_dpp v16, v52 quad_perm:[0,1,2,3] row_mask:2 bank_mask:0xf
    v_mov_b32_dpp v17, v56 quad_perm:[0,1,2,3] row_mask:2 bank_mask:0xf
    v_mov_b32_dpp v18, v60 quad_perm:[0,1,2,3] row_mask:2 bank_mask:0xf
    v_mov_b32_dpp v16, v64 quad_perm:[0,1,2,3] row_mask:4 bank_mask:0xf
    v_mov_b32_dpp v17, v68 quad_perm:[0,1,2,3] row_mask:4 bank_mask:0xf
    v_mov_b32_dpp v18, v72 quad_perm:[0,1,2,3] row_mask:4 bank_mask:0xf
    v_mov_b32_dpp v16, v76 quad_perm:[0,1,2,3] row_mask:8 bank_mask:0xf
    v_mov_b32_dpp v17, v80 quad_perm:[0,1,2,3] row_mask:8 bank_mask:0xf
    v_mov_b32_dpp v18, v84 quad_perm:[0,1,2,3] row_mask:8 bank_mask:0xf
    v_mov_b32_dpp v20, v41 quad_perm:[0,1,2,3] row_mask:1 bank_mask:0xf
    v_mov_b32_dpp v21, v45 quad_perm:[0,1,2,3] row_mask:1 bank_mask:0xf
    v_mov_b32_dpp v22, v49 quad_perm:[0,1,2,3] row_mask:1 bank_mask:0xf
    v_mov_b32_dpp v20, v53 quad_perm:[0,1,2,3] row_mask:2 bank_mask:0xf
    v_mov_b32_dpp v21, v57 quad_perm:[0,1,2,3] row_mask:2 bank_mask:0xf
    v_mov_b32_dpp v22, v61 quad_perm:[0,1,2,3] row_mask:2 bank_mask:0xf
    v_mov_b32_dpp v20, v65 quad_perm:[0,1,2,3] row_mask:4 bank_mask:0xf
    v_mov_b32_dpp v21, v69 quad_perm:[0,1,2,3] row_mask:4 bank_mask:0xf
    v_mov_b32_dpp v22, v73 quad_perm:[0,1,2,3] row_mask:4 bank_mask:0xf
    v_mov_b32_dpp v20, v77 quad_perm:[0,1,2,3] row_mask:8 bank_mask:0xf
    v_mov_b32_dpp v21, v81 quad_perm:[0,1,2,3] row_mask:8 bank_mask:0xf
    v_mov_b32_dpp v22, v85 quad_perm:[0,1,2,3] row_mask:8 bank_mask:0xf
    v_bitop3_b32 v19, v16, v17, v18 bitop3:0x96
    v_xor_b32 v19, s44, v19
    v_bitop3_b32 v23, v20, v21, v22 bitop3:0x96
    v_xor_b32 v23, s44, v23
    s_cmp_eq_u32 s50, 1
    s_cbranch_scc1 L_pl_200
    buffer_store_dwordx4 v[16:19], v2, s[52:55], s5 offen offset:0 sc1
    buffer_store_dwordx4 v[20:23], v2, s[52:55], s5 offen offset:1024 sc1
    s_branch L_st_201
L_pl_200:
    buffer_store_dwordx4 v[16:19], v2, s[52:55], s5 offen offset:0
    buffer_store_dwordx4 v[20:23], v2, s[52:55], s5 offen offset:1024
L_st_201:
    v_mov_b32 v3, 1556
    v_mov_b32 v4, 1
    ds_write_b32 v3, v4
L_Qg:
    s_bfe_u32 s9, s3, 0x10001
    s_and_b32 s4, s45, 30
    s_add_u32 s4, s4, s9
    s_lshl_b32 s4, s4, 14
    s_add_u32 s4, s4, 1966080
    s_mul_i32 s9, s9, 384
    s_add_u32 s5, s4, 4096
    s_add_u32 s6, s4, 8192
    s_add_u32 s7, s4, 12288
    s_mov_b32 s13, 4194304
    s_mov_b32 s8, 255
L_gat_202:
    s_bitcmp1_b32 s8, 0
    s_cbranch_scc0 L_sk_204
    buffer_load_dwordx4 v[40:43], v2, s[52:55], s4 offen offset:0 sc1
    buffer_load_dwordx4 v[44:47], v2, s[52:55], s4 offen offset:1024 sc1
L_sk_204:
    s_bitcmp1_b32 s8, 1
    s_cbranch_scc0 L_sk_205
    buffer_load_dwordx4 v[48:51], v2, s[52:55], s4 offen offset:2048 sc1
    buffer_load_dwordx4 v[52:55], v2, s[52:55], s4 offen offset:3072 sc1
L_sk_205:
    s_bitcmp1_b32 s8, 2
    s_cbranch_scc0 L_sk_206
    buffer_load_dwordx4 v[56:59], v2, s[52:55], s5 offen offset:0 sc1
    buffer_load_dwordx4 v[60:63], v2, s[52:55], s5 offen offset:1024 sc1
L_sk_206:
    s_bitcmp1_b32 s8, 3
    s_cbranch_scc0 L_sk_207
    buffer_load_dwordx4 v[64:67], v2, s[52:55], s5 offen offset:2048 sc1
    buffer_load_dwordx4 v[68:71], v2, s[52:55], s5 offen offset:3072 sc1
L_sk_207:
    s_bitcmp1_b32 s8, 4
    s_cbranch_scc0 L_sk_208
    buffer_load_dwordx4 v[72:75], v2, s[52:55], s6 offen offset:0 sc1
    buffer_load_dwordx4 v[76:79], v2, s[52:55], s6 offen offset:1024 sc1
L_sk_208:
    s_bitcmp1_b32 s8, 5
    s_cbranch_scc0 L_sk_209
    buffer_load_dwordx4 v[80:83], v2, s[52:55], s6 offen offset:2048 sc1
    buffer_load_dwordx4 v[84:87], v2, s[52:55], s6 offen offset:3072 sc1
L_sk_209:
    s_bitcmp1_b32 s8, 6
    s_cbranch_scc0 L_sk_210
    buffer_load_dwordx4 v[88:91], v2, s[52:55], s7 offen offset:0 sc1
    buffer_load_dwordx4 v[92:95], v2, s[52:55], s7 offen offset:1024 sc1
L_sk_210:
    s_bitcmp1_b32 s8, 7
    s_cbranch_scc0 L_sk_211
    buffer_load_dwordx4 v[96:99], v2, s[52:55], s7 offen offset:2048 sc1
    buffer_load_dwordx4 v[100:103], v2, s[52:55], s7 offen offset:3072 sc1
L_sk_211:
    s_mov_b32 s8, 0
    s_waitcnt vmcnt(0)
    v_bitop3_b32 v13, v96, v97, v98 bitop3:0x96
    v_xor_b32 v13, v13, v99
    v_xor_b32 v12, s44, v13
    v_bitop3_b32 v13, v100, v101, v102 bitop3:0x96
    v_xor_b32 v13, v13, v103
    v_bitop3_b32 v12, v13, s44, v12 bitop3:0xbe
    v_cmp_ne_u32 vcc, 0, v12
    s_nop 0
    s_cmp_lg_u64 vcc, 0
    s_addc_u32 s8, s8, s8
    v_bitop3_b32 v13, v88, v89, v90 bitop3:0x96
    v_xor_b32 v13, v13, v91
    v_xor_b32 v12, s44, v13
    v_bitop3_b32 v13, v92, v93, v94 bitop3:0x96
    v_xor_b32 v13, v13, v95
    v_bitop3_b32 v12, v13, s44, v12 bitop3:0xbe
    v_cmp_ne_u32 vcc, 0, v12
    s_nop 0
    s_cmp_lg_u64 vcc, 0
    s_addc_u32 s8, s8, s8
    v_bitop3_b32 v13, v80, v81, v82 bitop3:0x96
    v_xor_b32 v13, v13, v83
    v_xor_b32 v12, s44, v13
    v_bitop3_b32 v13, v84, v85, v86 bitop3:0x96
    v_xor_b32 v13, v13, v87
    v_bitop3_b32 v12, v13, s44, v12 bitop3:0xbe
    v_cmp_ne_u32 vcc, 0, v12
    s_nop 0
    s_cmp_lg_u64 vcc, 0
    s_addc_u32 s8, s8, s8
    v_bitop3_b32 v13, v72, v73, v74 bitop3:0x96
    v_xor_b32 v13, v13, v75
    v_xor_b32 v12, s44, v13
    v_bitop3_b32 v13, v76, v77, v78 bitop3:0x96
    v_xor_b32 v13, v13, v79
    v_bitop3_b32 v12, v13, s44, v12 bitop3:0xbe
    v_cmp_ne_u32 vcc, 0, v12
    s_nop 0
    s_cmp_lg_u64 vcc, 0
    s_addc_u32 s8, s8, s8
    v_bitop3_b32 v13, v64, v65, v66 bitop3:0x96
    v_xor_b32 v13, v13, v67
    v_xor_b32 v12, s44, v13
    v_bitop3_b32 v13, v68, v69, v70 bitop3:0x96
    v_xor_b32 v13, v13, v71
    v_bitop3_b32 v12, v13, s44, v12 bitop3:0xbe
    v_cmp_ne_u32 vcc, 0, v12
    s_nop 0
    s_cmp_lg_u64 vcc, 0
    s_addc_u32 s8, s8, s8
    v_bitop3_b32 v13, v56, v57, v58 bitop3:0x96
    v_xor_b32 v13, v13, v59
    v_xor_b32 v12, s44, v13
    v_bitop3_b32 v13, v60, v61, v62 bitop3:0x96
    v_xor_b32 v13, v13, v63
    v_bitop3_b32 v12, v13, s44, v12 bitop3:0xbe
    v_cmp_ne_u32 vcc, 0, v12
    s_nop 0
    s_cmp_lg_u64 vcc, 0
    s_addc_u32 s8, s8, s8
    v_bitop3_b32 v13, v48, v49, v50 bitop3:0x96
    v_xor_b32 v13, v13, v51
    v_xor_b32 v12, s44, v13
    v_bitop3_b32 v13, v52, v53, v54 bitop3:0x96
    v_xor_b32 v13, v13, v55
    v_bitop3_b32 v12, v13, s44, v12 bitop3:0xbe
    v_cmp_ne_u32 vcc, 0, v12
    s_nop 0
    s_cmp_lg_u64 vcc, 0
    s_addc_u32 s8, s8, s8
    v_bitop3_b32 v13, v40, v41, v42 bitop3:0x96
    v_xor_b32 v13, v13, v43
    v_xor_b32 v12, s44, v13
    v_bitop3_b32 v13, v44, v45, v46 bitop3:0x96
    v_xor_b32 v13, v13, v47
    v_bitop3_b32 v12, v13, s44, v12 bitop3:0xbe
    v_cmp_ne_u32 vcc, 0, v12
    s_nop 0
    s_cmp_lg_u64 vcc, 0
    s_addc_u32 s8, s8, s8
    s_cmp_eq_u32 s8, 0
    s_cbranch_scc1 L_ok_203
    s_sleep 8
    s_sub_u32 s13, s13, 1
    s_cbranch_scc0 L_gat_202
L_ok_203:
    v_lshrrev_b32 v3, 4, v0
    v_mul_u32_u24 v3, 96, v3
    v_and_b32 v4, 15, v0
    v_lshl_add_u32 v3, v4, 1, v3
    v_add_u32 v3, s9, v3
    v_pk_add_f32 v[40:41], v[40:41], v[48:49]
    v_add_f32 v42, v42, v50
    v_pk_add_f32 v[44:45], v[44:45], v[52:53]
    v_add_f32 v46, v46, v54
    v_pk_add_f32 v[40:41], v[40:41], v[56:57]
    v_add_f32 v42, v42, v58
    v_pk_add_f32 v[44:45], v[44:45], v[60:61]
    v_add_f32 v46, v46, v62
    v_pk_add_f32 v[40:41], v[40:41], v[64:65]
    v_add_f32 v42, v42, v66
    v_pk_add_f32 v[44:45], v[44:45], v[68:69]
    v_add_f32 v46, v46, v70
    v_pk_add_f32 v[40:41], v[40:41], v[72:73]
    v_add_f32 v42, v42, v74
    v_pk_add_f32 v[44:45], v[44:45], v[76:77]
    v_add_f32 v46, v46, v78
    v_pk_add_f32 v[40:41], v[40:41], v[80:81]
    v_add_f32 v42, v42, v82
    v_pk_add_f32 v[44:45], v[44:45], v[84:85]
    v_add_f32 v46, v46, v86
    v_pk_add_f32 v[40:41], v[40:41], v[88:89]
    v_add_f32 v42, v42, v90
    v_pk_add_f32 v[44:45], v[44:45], v[92:93]
    v_add_f32 v46, v46, v94
    v_pk_add_f32 v[40:41], v[40:41], v[96:97]
    v_add_f32 v42, v42, v98
    v_pk_add_f32 v[44:45], v[44:45], v[100:101]
    v_add_f32 v46, v46, v102
    v_cvt_pk_bf16_f32 v40, v40, v41
    v_cvt_pk_bf16_f32 v42, v42, v42
    ds_write_b16 v3, v40 offset:0
    ds_write_b16_d16_hi v3, v40 offset:32
    ds_write_b16 v3, v42 offset:64
    v_cvt_pk_bf16_f32 v44, v44, v45
    v_cvt_pk_bf16_f32 v46, v46, v46
    ds_write_b16 v3, v44 offset:768
    ds_write_b16_d16_hi v3, v44 offset:800
    ds_write_b16 v3, v46 offset:832
    s_waitcnt lgkmcnt(0)
    s_barrier
    s_cmp_eq_u32 s3, 11
    s_cbranch_scc1 L_s3b
    s_bitcmp1_b32 s15, 1
    s_cbranch_scc1 L_s1C_212
    s_bitcmp1_b32 s15, 3
    s_cbranch_scc1 L_s1D_213
    s_bitcmp1_b32 s15, 0
    s_cbranch_scc0 L_s1W_214
    s_mov_b32 s12, 0
    v_mov_b32 v1, 0
    v_mov_b32 v2, 0
    v_mov_b32 v3, 0
    v_mov_b32 v4, 0
    v_mov_b32 v5, 0
    v_mov_b32 v6, 0
    v_mov_b32 v7, 0
    s_mov_b64 exec, 0
    s_branch L_B
L_wB:
    s_mov_b64 exec, -1
    v_mov_b32 v1, 0
    v_mov_b32 v2, 0
    v_mov_b32 v3, 0
    v_mov_b32 v4, 0
    v_mov_b32 v5, 0
    v_mov_b32 v6, 0
    v_mov_b32 v7, 0
    s_mov_b64 exec, 0
    s_branch L_Bg
L_wBg:
    s_mov_b64 exec, -1
    s_branch L_s1W_214
L_s1C_212:
    s_mov_b32 s12, 0
    v_mov_b32 v1, 0
    v_mov_b32 v2, 0
    v_mov_b32 v3, 0
    v_mov_b32 v4, 0
    v_mov_b32 v5, 0
    v_mov_b32 v6, 0
    v_mov_b32 v7, 0
    s_mov_b64 exec, 0
    s_branch L_C
L_wC:
    s_mov_b64 exec, -1
    s_branch L_s1W_214
L_s1D_213:
    s_mov_b32 s12, 11
    v_mov_b32 v1, 0
    v_mov_b32 v2, 0
    v_mov_b32 v3, 0
    v_mov_b32 v4, 0
    v_mov_b32 v5, 0
    v_mov_b32 v6, 0
    v_mov_b32 v7, 0
    s_mov_b64 exec, 0
    s_branch L_D
L_wD:
    s_mov_b64 exec, -1
L_s1W_214:
    s_mov_b32 s12, 9
    v_mov_b32 v101, 0
    s_mov_b32 s11, 4096
    s_lshl_b32 s72, s48, 7
    s_add_u32 s72, s72, 2048
    s_mov_b32 s75, 130
    s_cmp_lt_u32 s49, 11
    s_cselect_b32 s78, 8, 6
    s_cselect_b32 s79, 20, 17
    s_cselect_b32 s74, 0, 22
    s_add_u32 s74, s74, 42
    s_lshl_b32 s5, s49, 3
    s_add_u32 s5, s5, s48
    s_mul_i32 s5, s5, s78
    s_lshr_b32 s5, s5, 3
    s_add_u32 s74, s74, s5
    s_add_u32 s79, s79, s44
    v_and_b32 v100, 31, v0
    v_lshlrev_b32 v100, 2, v100
    s_lshl_b32 s73, s48, 12
    s_add_u32 s73, s73, 131072
    s_mov_b32 s10, 131072
    v_and_b32 v105, 7, v0
    v_cmp_eq_u32 s[76:77], s48, v105
    v_lshlrev_b32 v105, 12, v105
    v_mov_b32 v106, 36
    v_xor_b32 v104, 4096, v105
    v_cndmask_b32_e64 v105, v105, v104, s[76:77]
    s_and_b32 s8, s15, 1
    s_mul_i32 s8, s8, 1
    s_sub_u32 s8, s44, s8
L_bal_215:
    buffer_load_dword v103, v101, s[52:55], s72 offen sc1
    s_waitcnt vmcnt(0)
    ds_read_b32 v102, v101 offset:1544
    v_subrev_u32 v103, s8, v103
    ds_write_b32 v101, v103 offset:1552
    s_waitcnt lgkmcnt(0)
    v_readfirstlane_b32 s9, v102
    s_nop 0
    s_cmp_ge_u32 s9, s75
    s_cbranch_scc0 L_nost_218
    s_mov_b32 s75, 999
    s_mov_b32 s5, 3
    v_lshlrev_b32 v2, 4, v0
    s_lshr_b32 s6, s45, 1
    s_lshl2_add_u32 s6, s6, s5
    s_lshl_b32 s4, s6, 11
    s_add_u32 s4, s4, 1572864
    s_mov_b32 s13, 4194304
L_poll_219:
    buffer_load_dwordx3 v[4:6], v2, s[52:55], s4 offen offset:0 sc1
    buffer_load_dwordx3 v[8:10], v2, s[52:55], s4 offen offset:1024 sc1
    s_waitcnt vmcnt(1)
    v_bitop3_b32 v13, v4, v5, v6 bitop3:0x96
    v_xor_b32 v12, s44, v13
    s_waitcnt vmcnt(0)
    v_bitop3_b32 v13, v8, v9, v10 bitop3:0x96
    v_bitop3_b32 v12, v13, s44, v12 bitop3:0xbe
    v_cmp_ne_u32 vcc, 0, v12
    s_nop 0
    s_cbranch_vccz L_ok_220
    s_sleep 32
    s_sub_u32 s13, s13, 1
    s_cbranch_scc0 L_poll_219
L_ok_220:
    v_max_f32 v12, v4, v8
    s_nop 1
    v_max_f32_dpp v12, v12, v12 quad_perm:[1,0,3,2] row_mask:0xf bank_mask:0xf
    s_nop 1
    v_max_f32_dpp v12, v12, v12 quad_perm:[2,3,0,1] row_mask:0xf bank_mask:0xf
    s_nop 1
    v_max_f32_dpp v12, v12, v12 row_half_mirror row_mask:0xf bank_mask:0xf
    s_nop 1
    v_max_f32_dpp v12, v12, v12 row_mirror row_mask:0xf bank_mask:0xf
    v_mov_b32 v13, v12
    s_nop 1
    v_permlane16_swap_b32 v12, v13
    v_max_f32 v12, v12, v13
    v_mov_b32 v13, v12
    s_nop 1
    v_permlane32_swap_b32 v12, v13
    v_max_f32 v12, v12, v13
    v_sub_f32 v4, v4, v12
    v_mul_f32 v4, 0x3fb8aa3b, v4
    v_exp_f32 v4, v4
    v_sub_f32 v8, v8, v12
    v_mul_f32 v8, 0x3fb8aa3b, v8
    v_exp_f32 v8, v8
    v_mul_f32 v5, v5, v4
    v_fmac_f32 v5, v9, v8
    s_nop 1
    v_add_f32_dpp v5, v5, v5 quad_perm:[1,0,3,2] row_mask:0xf bank_mask:0xf
    s_nop 1
    v_add_f32_dpp v5, v5, v5 quad_perm:[2,3,0,1] row_mask:0xf bank_mask:0xf
    s_nop 1
    v_add_f32_dpp v5, v5, v5 row_half_mirror row_mask:0xf bank_mask:0xf
    s_nop 1
    v_add_f32_dpp v5, v5, v5 row_mirror row_mask:0xf bank_mask:0xf
    v_mov_b32 v13, v5
    s_nop 1
    v_permlane16_swap_b32 v5, v13
    v_add_f32 v5, v5, v13
    v_mov_b32 v13, v5
    s_nop 1
    v_permlane32_swap_b32 v5, v13
    v_add_f32 v5, v5, v13
    v_rcp_f32 v5, v5
    s_bitcmp1_b32 s45, 0
    s_cselect_b64 vcc, -1, 0
    v_cndmask_b32 v4, v4, v8, vcc
    v_mul_f32 v4, v4, v5
    s_lshl_b32 s4, s46, 3
    v_readlane_b32 s64, v4, s4
    s_add_u32 s4, s4, 1
    v_readlane_b32 s65, v4, s4
    s_add_u32 s4, s4, 1
    v_readlane_b32 s66, v4, s4
    s_add_u32 s4, s4, 1
    v_readlane_b32 s67, v4, s4
    s_add_u32 s4, s4, 1
    v_readlane_b32 s68, v4, s4
    s_add_u32 s4, s4, 1
    v_readlane_b32 s69, v4, s4
    s_add_u32 s4, s4, 1
    v_readlane_b32 s70, v4, s4
    s_add_u32 s4, s4, 1
    v_readlane_b32 s71, v4, s4
    s_mul_i32 s4, s5, 12288
    s_add_u32 s4, s4, 9216
    v_lshl_add_u32 v1, v0, 2, s4
    s_lshl_b32 s7, s5, 2
    s_lshr_b32 s7, 0x3210, s7
    s_bfe_u32 s4, s7, 0x10001
    s_mul_i32 s4, s4, 832
    s_and_b32 s7, s7, 1
    s_mul_i32 s7, s7, 384
    s_add_u32 s4, s4, s7
    s_add_u32 s4, s4, 2816
    v_lshl_add_u32 v3, v0, 1, s4
    s_lshl_b32 s6, s6, 14
    s_add_u32 s6, s6, 524288
    s_and_b32 s4, s49, 15
    s_lshl_b32 s4, s4, 10
    s_add_u32 s4, s4, s6
    s_add_u32 s7, s6, 4096
    s_branch L_bal_215
L_nost_218:
    s_cmp_ge_u32 s9, 183
    s_cbranch_scc1 L_balE_216
    s_cmp_ge_u32 s9, s74
    s_cbranch_scc0 L_nox_217
    s_mov_b32 s74, 999
    v_add_u32 v103, s44, v102
    buffer_load_dword v104, v105, s[52:55], s10 offen sc1
    buffer_store_dword v103, v100, s[52:55], s73 offen sc1
    s_waitcnt vmcnt(1)
    v_subrev_u32 v104, s44, v104
    v_cmp_lt_u32 vcc, 192, v104
    s_nop 1
    v_cndmask_b32 v104, v104, v106, vcc
    v_subrev_u32 v102, s78, v102
    v_cndmask_b32_e64 v104, v104, v102, s[76:77]
    s_cmp_lt_u32 s49, 11
    s_cselect_b32 s9, 6, 3
    v_add_u32 v107, s9, v104
    v_add_u32_dpp v104, v104, v104 quad_perm:[1,0,3,2] row_mask:0xf bank_mask:0xf
    s_nop 0
    v_min_u32_dpp v107, v107, v107 quad_perm:[1,0,3,2] row_mask:0xf bank_mask:0xf
    v_add_u32_dpp v104, v104, v104 quad_perm:[2,3,0,1] row_mask:0xf bank_mask:0xf
    s_nop 0
    v_min_u32_dpp v107, v107, v107 quad_perm:[2,3,0,1] row_mask:0xf bank_mask:0xf
    v_add_u32_dpp v104, v104, v104 row_half_mirror row_mask:0xf bank_mask:0xf
    s_nop 0
    v_min_u32_dpp v107, v107, v107 row_half_mirror row_mask:0xf bank_mask:0xf
    v_lshrrev_b32 v104, 3, v104
    v_min_u32 v104, v104, v107
    v_add_u32 v104, s79, v104
    buffer_store_dword v104, v100, s[52:55], s72 offen
L_nox_217:
    s_sleep 12
    s_sub_u32 s11, s11, 1
    s_cbranch_scc0 L_bal_215
    s_mov_b32 s5, 3
    v_lshlrev_b32 v2, 4, v0
    s_lshr_b32 s6, s45, 1
    s_lshl2_add_u32 s6, s6, s5
    s_lshl_b32 s4, s6, 11
    s_add_u32 s4, s4, 1572864
    s_mov_b32 s13, 4194304
L_poll_222:
    buffer_load_dwordx3 v[4:6], v2, s[52:55], s4 offen offset:0 sc1
    buffer_load_dwordx3 v[8:10], v2, s[52:55], s4 offen offset:1024 sc1
    s_waitcnt vmcnt(1)
    v_bitop3_b32 v13, v4, v5, v6 bitop3:0x96
    v_xor_b32 v12, s44, v13
    s_waitcnt vmcnt(0)
    v_bitop3_b32 v13, v8, v9, v10 bitop3:0x96
    v_bitop3_b32 v12, v13, s44, v12 bitop3:0xbe
    v_cmp_ne_u32 vcc, 0, v12
    s_nop 0
    s_cbranch_vccz L_ok_223
    s_sleep 32
    s_sub_u32 s13, s13, 1
    s_cbranch_scc0 L_poll_222
L_ok_223:
    v_max_f32 v12, v4, v8
    s_nop 1
    v_max_f32_dpp v12, v12, v12 quad_perm:[1,0,3,2] row_mask:0xf bank_mask:0xf
    s_nop 1
    v_max_f32_dpp v12, v12, v12 quad_perm:[2,3,0,1] row_mask:0xf bank_mask:0xf
    s_nop 1
    v_max_f32_dpp v12, v12, v12 row_half_mirror row_mask:0xf bank_mask:0xf
    s_nop 1
    v_max_f32_dpp v12, v12, v12 row_mirror row_mask:0xf bank_mask:0xf
    v_mov_b32 v13, v12
    s_nop 1
    v_permlane16_swap_b32 v12, v13
    v_max_f32 v12, v12, v13
    v_mov_b32 v13, v12
    s_nop 1
    v_permlane32_swap_b32 v12, v13
    v_max_f32 v12, v12, v13
    v_sub_f32 v4, v4, v12
    v_mul_f32 v4, 0x3fb8aa3b, v4
    v_exp_f32 v4, v4
    v_sub_f32 v8, v8, v12
    v_mul_f32 v8, 0x3fb8aa3b, v8
    v_exp_f32 v8, v8
    v_mul_f32 v5, v5, v4
    v_fmac_f32 v5, v9, v8
    s_nop 1
    v_add_f32_dpp v5, v5, v5 quad_perm:[1,0,3,2] row_mask:0xf bank_mask:0xf
    s_nop 1
    v_add_f32_dpp v5, v5, v5 quad_perm:[2,3,0,1] row_mask:0xf bank_mask:0xf
    s_nop 1
    v_add_f32_dpp v5, v5, v5 row_half_mirror row_mask:0xf bank_mask:0xf
    s_nop 1
    v_add_f32_dpp v5, v5, v5 row_mirror row_mask:0xf bank_mask:0xf
    v_mov_b32 v13, v5
    s_nop 1
    v_permlane16_swap_b32 v5, v13
    v_add_f32 v5, v5, v13
    v_mov_b32 v13, v5
    s_nop 1
    v_permlane32_swap_b32 v5, v13
    v_add_f32 v5, v5, v13
    v_rcp_f32 v5, v5
    s_bitcmp1_b32 s45, 0
    s_cselect_b64 vcc, -1, 0
    v_cndmask_b32 v4, v4, v8, vcc
    v_mul_f32 v4, v4, v5
    s_lshl_b32 s4, s46, 3
    v_readlane_b32 s64, v4, s4
    s_add_u32 s4, s4, 1
    v_readlane_b32 s65, v4, s4
    s_add_u32 s4, s4, 1
    v_readlane_b32 s66, v4, s4
    s_add_u32 s4, s4, 1
    v_readlane_b32 s67, v4, s4
    s_add_u32 s4, s4, 1
    v_readlane_b32 s68, v4, s4
    s_add_u32 s4, s4, 1
    v_readlane_b32 s69, v4, s4
    s_add_u32 s4, s4, 1
    v_readlane_b32 s70, v4, s4
    s_add_u32 s4, s4, 1
    v_readlane_b32 s71, v4, s4
    s_mul_i32 s4, s5, 12288
    s_add_u32 s4, s4, 9216
    v_lshl_add_u32 v1, v0, 2, s4
    s_lshl_b32 s7, s5, 2
    s_lshr_b32 s7, 0x3210, s7
    s_bfe_u32 s4, s7, 0x10001
    s_mul_i32 s4, s4, 832
    s_and_b32 s7, s7, 1
    s_mul_i32 s7, s7, 384
    s_add_u32 s4, s4, s7
    s_add_u32 s4, s4, 2816
    v_lshl_add_u32 v3, v0, 1, s4
    s_lshl_b32 s6, s6, 14
    s_add_u32 s6, s6, 524288
    s_and_b32 s4, s49, 15
    s_lshl_b32 s4, s4, 10
    s_add_u32 s4, s4, s6
    s_add_u32 s7, s6, 4096
L_balE_216:
    s_add_u32 s6, s6, 8192
    s_add_u32 s7, s7, 8192
    v_add_u32 v3, 1664, v3
    s_barrier
    s_branch L_T0
L_s2:
    s_getreg_b32 s4, hwreg(HW_REG_XCC_ID)
    v_and_b32 v1, 31, v0
    v_lshlrev_b32 v1, 3, v1
    s_lshl_b32 s5, s48, 8
    s_add_u32 s5, s5, 36864
    s_lshl3_add_u32 s6, s49, s5
    s_waitcnt lgkmcnt(0)
    s_add_u32 s44, s44, 0x9e3779b1
    v_mov_b32 v2, s4
    v_mov_b32 v3, s44
    s_mov_b64 exec, 1
    s_add_u32 s7, s6, -28672
    buffer_store_dwordx2 v[2:3], v1, s[52:55], s7 offen
    buffer_store_dwordx2 v[2:3], v1, s[52:55], s6 offen sc1
    s_mov_b64 exec, -1
    s_add_u32 s7, s5, -28672
    s_mov_b32 s13, 6
L_poll_226:
    buffer_load_dwordx2 v[4:5], v1, s[52:55], s7 offen sc1
    s_waitcnt vmcnt(0)
    v_xor_b32 v6, s44, v5
    v_cmp_ne_u32 vcc, 0, v6
    s_nop 0
    s_cbranch_vccz L_ok_227
    s_sleep 8
    s_sub_u32 s13, s13, 1
    s_cbranch_scc0 L_poll_226
L_ok_227:
    s_cbranch_vccz L_gotid_225
    s_mov_b32 s13, 4194304
L_poll_229:
    buffer_load_dwordx2 v[4:5], v1, s[52:55], s5 offen sc1
    s_waitcnt vmcnt(0)
    v_xor_b32 v6, s44, v5
    v_cmp_ne_u32 vcc, 0, v6
    s_nop 0
    s_cbranch_vccz L_ok_230
    s_sleep 8
    s_sub_u32 s13, s13, 1
    s_cbranch_scc0 L_poll_229
L_ok_230:
L_gotid_225:
    v_xor_b32 v4, s4, v4
    v_or_b32 v4, v4, v6
    v_cmp_ne_u32 vcc, 0, v4
    s_nop 0
    s_cmp_eq_u64 vcc, 0
    s_cselect_b32 s4, 2, 1
    v_mov_b32 v4, s4
    v_mov_b32 v5, 1536
    ds_write_b32 v5, v4
    s_waitcnt lgkmcnt(0)
    s_barrier
    s_bitcmp1_b32 s15, 1
    s_cbranch_scc1 L_LN0
    s_bitcmp1_b32 s15, 0
    s_cbranch_scc0 L_s23
    v_mov_b32 v1, 0
    v_mov_b32 v2, 0
    v_mov_b32 v3, 0
    v_mov_b32 v4, 0
    v_mov_b32 v5, 0
    v_mov_b32 v6, 0
    v_mov_b32 v7, 0
    s_mov_b64 exec, 0
    s_branch L_R
L_wR:
    s_mov_b64 exec, -1
L_R0:
    v_mov_b32 v1, 0
    s_mov_b32 s13, 4194304
L_prog_232:
    s_sleep 32
    ds_read_b32 v2, v1 offset:1544
    s_sub_u32 s13, s13, 1
    s_waitcnt lgkmcnt(0)
    v_readfirstlane_b32 s4, v2
    s_nop 0
    s_cselect_b32 s4, 999, s4
    s_cmp_lt_u32 s4, 72
    s_cbranch_scc1 L_prog_232
    v_mov_b32 v1, 1536
    ds_read_b32 v1, v1
    s_waitcnt lgkmcnt(0)
    v_readfirstlane_b32 s50, v1
    s_nop 0
    s_sub_u32 s50, s50, 1
    s_mov_b32 s56, s16
    s_mov_b32 s57, s17
    s_mov_b32 s58, 2560
    s_mov_b32 s59, 0x20000
    v_and_b32 v1, 15, v0
    v_lshlrev_b32 v2, 1, v1
    s_lshl_b32 s5, s51, 5
    buffer_load_ushort v4, v2, s[56:59], s5 offen
    buffer_load_ushort v5, v2, s[56:59], s5 offen offset:1280
    v_lshlrev_b32 v2, 3, v1
    s_lshl_b32 s5, s51, 7
    s_add_u32 s6, s5, 14336
    s_mov_b32 s13, 4194304
L_poll_235:
    buffer_load_dwordx2 v[6:7], v2, s[52:55], s6 offen sc1
    s_waitcnt vmcnt(0)
    v_xor_b32 v8, s44, v7
    v_cmp_ne_u32 vcc, 0, v8
    s_nop 0
    s_cbranch_vccz L_ok_236
    s_sleep 32
    s_sub_u32 s13, s13, 1
    s_cbranch_scc0 L_poll_235
L_ok_236:
    v_lshlrev_b32 v4, 16, v4
    v_lshlrev_b32 v5, 16, v5
    v_and_b32 v7, 0xffff0000, v6
    v_lshlrev_b32 v6, 16, v6
    s_add_u32 s5, s5, 65536
    v_mov_b32 v9, s44
    s_lshl_b32 s6, s48, 13
    s_add_u32 s5, s5, s6
    v_lshrrev_b32 v3, 4, v0
    v_mul_u32_u24 v3, 10240, v3
    v_and_b32 v8, 15, v0
    v_lshl_add_u32 v3, v8, 4, v3
    s_lshl_b32 s64, s51, 8
    s_add_u32 s64, s64, 360448
    s_sub_u32 s64, s64, 163840
    s_sub_u32 s6, 1, s50
    s_mul_i32 s6, s6, 163840
    v_mov_b32 v12, s6
    v_mov_b32 v13, 163840
    v_lshrrev_b32 v14, 5, v0
    v_add_u32 v15, 0, v14
    v_cmp_eq_u32 vcc, s48, v15
    s_nop 1
    v_cndmask_b32 v15, v13, v12, vcc
    v_add_u32 v15, 0, v15
    v_add_u32 v32, v15, v3
    v_add_u32 v15, 2, v14
    v_cmp_eq_u32 vcc, s48, v15
    s_nop 1
    v_cndmask_b32 v15, v13, v12, vcc
    v_add_u32 v15, 40960, v15
    v_add_u32 v33, v15, v3
    v_add_u32 v15, 4, v14
    v_cmp_eq_u32 vcc, s48, v15
    s_nop 1
    v_cndmask_b32 v15, v13, v12, vcc
    v_add_u32 v15, 81920, v15
    v_add_u32 v34, v15, v3
    v_add_u32 v15, 6, v14
    v_cmp_eq_u32 vcc, s48, v15
    s_nop 1
    v_cndmask_b32 v15, v13, v12, vcc
    v_add_u32 v15, 122880, v15
    v_add_u32 v35, v15, v3
    s_lshr_b32 s4, s45, 1
    v_lshrrev_b32 v14, 4, v0
    s_bfe_u32 s6, s45, 0x10001
    s_mul_i32 s6, s6, 4294946816
    s_add_u32 s6, s6, 10240
    v_add_u32 v15, 0, v14
    v_cmp_eq_u32 s[66:67], s4, v15
    v_add_u32 v15, s6, v32
    s_nop 0
    v_cndmask_b32_e64 v32, v32, v15, s[66:67]
    v_add_u32 v15, 4, v14
    v_cmp_eq_u32 s[68:69], s4, v15
    v_add_u32 v15, s6, v33
    s_nop 0
    v_cndmask_b32_e64 v33, v33, v15, s[68:69]
    v_add_u32 v15, 8, v14
    v_cmp_eq_u32 s[70:71], s4, v15
    v_add_u32 v15, s6, v34
    s_nop 0
    v_cndmask_b32_e64 v34, v34, v15, s[70:71]
    v_add_u32 v15, 12, v14
    v_cmp_eq_u32 s[72:73], s4, v15
    v_add_u32 v15, s6, v35
    s_nop 0
    v_cndmask_b32_e64 v35, v35, v15, s[72:73]
    s_and_b32 s4, s51, 3
    s_lshl_b32 s4, s4, 7
    s_add_u32 s4, s4, 1664
    v_add_u32 v36, s4, v2
    s_mov_b32 s60, s24
    s_mov_b32 s61, s25
    s_mov_b32 s62, 7864320
    s_mov_b32 s63, 0x20000
    v_lshrrev_b32 v46, 3, v0
    v_mul_u32_u24 v44, 1280, v46
    v_and_b32 v46, 2, v46
    v_and_b32 v45, 7, v0
    v_xor_b32 v46, v46, v45
    v_xor_b32 v45, 4, v46
    s_bitcmp1_b32 s3, 0
    s_cselect_b64 vcc, -1, 0
    v_cndmask_b32 v46, v46, v45, vcc
    v_lshl_add_u32 v44, v46, 4, v44
    s_lshr_b32 s8, s2, 7
    s_lshl3_add_u32 s8, s8, s48
    s_mul_i32 s8, s8, 245760
    s_lshr_b32 s9, s51, 2
    s_lshl_b32 s9, s9, 7
    s_add_u32 s8, s8, s9
    s_add_u32 s8, s8, 3932160
    s_and_b32 s9, s3, 1
    s_mul_i32 s10, s9, 10240
    s_add_u32 s8, s8, s10
    s_lshl_b32 s9, s9, 10
    s_add_u32 s9, s9, 134144
    v_mov_b32 v12, 0
    s_mov_b32 s13, 4194304
L_prog_238:
    s_sleep 32
    ds_read_b32 v13, v12 offset:1544
    s_sub_u32 s13, s13, 1
    s_waitcnt lgkmcnt(0)
    v_readfirstlane_b32 s4, v13
    s_nop 0
    s_cselect_b32 s4, 999, s4
    s_cmp_lt_u32 s4, 180
    s_cbranch_scc1 L_prog_238
    v_mov_b32 v12, 0
    s_mov_b32 s13, 4194304
L_prog_239:
    s_sleep 1
    ds_read_b32 v13, v12 offset:1580
    s_sub_u32 s13, s13, 1
    s_waitcnt lgkmcnt(0)
    v_readfirstlane_b32 s4, v13
    s_nop 0
    s_cselect_b32 s4, 999, s4
    s_cmp_lt_u32 s4, 8
    s_cbranch_scc1 L_prog_239
    s_mov_b32 m0, s9
    s_add_u32 s9, s9, 2048
    buffer_load_dwordx4 v44, s[60:63], s8 offen nt lds
    s_add_u32 s8, s8, 20480
    s_mov_b32 m0, s9
    s_add_u32 s9, s9, 2048
    buffer_load_dwordx4 v44, s[60:63], s8 offen nt lds
    s_add_u32 s8, s8, 20480
    s_mov_b32 m0, s9
    s_add_u32 s9, s9, 2048
    buffer_load_dwordx4 v44, s[60:63], s8 offen nt lds
    s_add_u32 s8, s8, 20480
    s_mov_b32 m0, s9
    s_add_u32 s9, s9, 2048
    buffer_load_dwordx4 v44, s[60:63], s8 offen nt lds
    s_add_u32 s8, s8, 20480
    s_mov_b32 m0, s9
    s_add_u32 s9, s9, 2048
    buffer_load_dwordx4 v44, s[60:63], s8 offen nt lds
    s_add_u32 s8, s8, 20480
    s_mov_b32 m0, s9
    s_add_u32 s9, s9, 2048
    buffer_load_dwordx4 v44, s[60:63], s8 offen nt lds
    s_add_u32 s8, s8, 20480
    s_mov_b32 m0, s9
    s_add_u32 s9, s9, 2048
    buffer_load_dwordx4 v44, s[60:63], s8 offen nt lds
    s_add_u32 s8, s8, 20480
    s_mov_b32 m0, s9
    s_add_u32 s9, s9, 2048
    buffer_load_dwordx4 v44, s[60:63], s8 offen nt lds
    s_add_u32 s8, s8, 20480
    s_mov_b32 m0, s9
    s_add_u32 s9, s9, 2048
    buffer_load_dwordx4 v44, s[60:63], s8 offen nt lds
    s_add_u32 s8, s8, 20480
    s_mov_b32 m0, s9
    s_add_u32 s9, s9, 2048
    buffer_load_dwordx4 v44, s[60:63], s8 offen nt lds
    s_add_u32 s8, s8, 20480
    s_mov_b32 m0, s9
    s_add_u32 s9, s9, 2048
    buffer_load_dwordx4 v44, s[60:63], s8 offen nt lds
    s_add_u32 s8, s8, 20480
    s_mov_b32 m0, s9
    s_add_u32 s9, s9, 2048
    buffer_load_dwordx4 v44, s[60:63], s8 offen nt lds
    s_add_u32 s8, s8, 20480
    s_barrier
    s_waitcnt vmcnt(0)
    s_mov_b64 exec, 1
    v_mov_b32 v12, 0
    v_mov_b32 v13, 1
    ds_add_u32 v12, v13 offset:1584
    s_mov_b64 exec, -1
    s_barrier
    buffer_load_dword v40, v32, s[52:55], s64 offen sc1
    buffer_load_dword v41, v33, s[52:55], s64 offen sc1
    buffer_load_dword v42, v34, s[52:55], s64 offen sc1
    buffer_load_dword v43, v35, s[52:55], s64 offen sc1
    s_barrier
L_R:
    ds_read_b64 v[38:39], v36
    s_mov_b32 s13, 4194304
L_poll_240:
    s_cbranch_execz L_lv_243
    buffer_load_dwordx3 v[16:18], v32, s[52:55], s64 offen sc1
    buffer_load_dwordx3 v[20:22], v33, s[52:55], s64 offen sc1
    buffer_load_dwordx3 v[24:26], v34, s[52:55], s64 offen sc1
    buffer_load_dwordx3 v[28:30], v35, s[52:55], s64 offen sc1
L_lv_243:
    s_waitcnt vmcnt(3)
    v_bitop3_b32 v13, v16, v17, v18 bitop3:0x96
    v_xor_b32 v12, s44, v13
    s_waitcnt lgkmcnt(0)
    v_cndmask_b32_e64 v16, v16, v38, s[66:67]
    v_cndmask_b32_e64 v17, v17, v39, s[66:67]
    s_waitcnt vmcnt(2)
    v_bitop3_b32 v13, v20, v21, v22 bitop3:0x96
    v_bitop3_b32 v12, v13, s44, v12 bitop3:0xbe
    v_cndmask_b32_e64 v20, v20, v38, s[68:69]
    v_cndmask_b32_e64 v21, v21, v39, s[68:69]
    v_pk_add_f32 v[10:11], v[16:17], v[20:21]
    s_waitcnt vmcnt(1)
    v_bitop3_b32 v13, v24, v25, v26 bitop3:0x96
    v_bitop3_b32 v12, v13, s44, v12 bitop3:0xbe
    v_cndmask_b32_e64 v24, v24, v38, s[70:71]
    v_cndmask_b32_e64 v25, v25, v39, s[70:71]
    v_pk_add_f32 v[10:11], v[10:11], v[24:25]
    s_waitcnt vmcnt(0)
    v_bitop3_b32 v13, v28, v29, v30 bitop3:0x96
    v_bitop3_b32 v12, v13, s44, v12 bitop3:0xbe
    v_cndmask_b32_e64 v28, v28, v38, s[72:73]
    v_cndmask_b32_e64 v29, v29, v39, s[72:73]
    v_pk_add_f32 v[10:11], v[10:11], v[28:29]
    v_cmp_ne_u32 vcc, 0, v12
    s_nop 0
    s_cbranch_vccz L_ok_241
    s_sub_u32 s13, s13, 1
    s_cbranch_scc0 L_poll_240
L_ok_241:
    v_mov_b32 v14, v10
    v_mov_b32 v15, v11
    s_nop 0
    v_permlane16_swap_b32 v10, v14
    v_permlane16_swap_b32 v11, v15
    v_pk_add_f32 v[10:11], v[10:11], v[14:15]
    v_mov_b32 v14, v10
    v_mov_b32 v15, v11
    s_nop 0
    v_permlane32_swap_b32 v10, v14
    v_permlane32_swap_b32 v11, v15
    v_pk_add_f32 v[10:11], v[10:11], v[14:15]
    v_pk_fma_f32 v[10:11], v[10:11], v[6:7], v[4:5]
    v_cvt_pk_bf16_f32 v8, v10, v11
    s_cbranch_execz L_wR
    s_mov_b64 exec, 0xffff
    s_cmp_eq_u32 s50, 1
    s_cbranch_scc1 L_pl_244
    buffer_store_dwordx2 v[8:9], v2, s[52:55], s5 offen sc1
    s_branch L_st_245
L_pl_244:
    buffer_store_dwordx2 v[8:9], v2, s[52:55], s5 offen
L_st_245:
    s_endpgm
L_s3:
    s_waitcnt lgkmcnt(0)
    s_add_u32 s44, s44, 0x9e3779b1
    v_mov_b32 v3, 1560
    s_mov_b32 s13, 4194304
L_lw_246:
    s_sleep 1
    ds_read_b32 v4, v3
    s_sub_u32 s13, s13, 1
    s_waitcnt lgkmcnt(0)
    v_readfirstlane_b32 s10, v4
    s_nop 0
    s_cselect_b32 s10, 1, s10
    s_cmp_eq_u32 s10, 1
    s_cbranch_scc0 L_lw_246
    s_bitcmp1_b32 s15, 0
    s_cbranch_scc0 L_stD_247
    s_mov_b32 s56, s24
    s_mov_b32 s57, s25
    s_mov_b32 s58, 7864320
    s_mov_b32 s59, 0x20000
    v_lshrrev_b32 v2, 3, v0
    v_mul_u32_u24 v1, 1280, v2
    v_and_b32 v2, 2, v2
    v_and_b32 v3, 7, v0
    v_xor_b32 v2, v2, v3
    v_xor_b32 v3, 4, v2
    v_lshl_add_u32 v3, v3, 4, v1
    v_lshl_add_u32 v1, v2, 4, v1
    s_lshr_b32 s5, s2, 7
    s_lshl3_add_u32 s5, s5, s48
    s_mul_i32 s5, s5, 245760
    s_and_b32 s4, s45, 1
    s_mul_i32 s4, s4, 5
    s_add_u32 s4, s4, s46
    s_lshl_b32 s4, s4, 7
    s_add_u32 s5, s5, s4
    s_add_u32 s5, s5, 0
    s_mov_b32 s4, 109568
L_dma_250:
    s_mov_b32 m0, s4
    s_waitcnt vmcnt(59)
    buffer_load_dwordx4 v1, s[56:59], s5 offen nt lds
    s_add_u32 s5, s5, 10240
    s_add_u32 s4, s4, 1024
    s_mov_b32 m0, s4
    s_waitcnt vmcnt(59)
    buffer_load_dwordx4 v3, s[56:59], s5 offen nt lds
    s_add_u32 s5, s5, 10240
    s_add_u32 s4, s4, 1024
    s_cmp_lt_u32 s4, 134144
    s_cbranch_scc1 L_dma_250
    s_branch L_stE_249
L_stD_247:
    s_bitcmp1_b32 s15, 3
    s_cbranch_scc0 L_stC_248
    s_mov_b32 s56, s32
    s_mov_b32 s57, s33
    s_mov_b32 s58, 1966080
    s_mov_b32 s59, 0x20000
    v_lshrrev_b32 v1, 2, v0
    v_mul_u32_u24 v1, 1280, v1
    v_and_b32 v2, 3, v0
    v_lshl_add_u32 v1, v2, 4, v1
    s_lshl_b32 s4, s14, 6
    s_add_u32 s4, s4, 1474560
    s_mov_b32 m0, 132096
    s_nop 0
    buffer_load_dwordx4 v1, s[56:59], s4 offen nt lds
    s_add_u32 s4, s4, 20480
    s_mov_b32 m0, 133120
    s_nop 0
    buffer_load_dwordx4 v1, s[56:59], s4 offen nt lds
    s_add_u32 s4, s4, 20480
    s_mov_b32 m0, 134144
    s_nop 0
    buffer_load_dwordx4 v1, s[56:59], s4 offen nt lds
    s_add_u32 s4, s4, 20480
    s_mov_b32 m0, 135168
    s_nop 0
    buffer_load_dwordx4 v1, s[56:59], s4 offen nt lds
    s_add_u32 s4, s4, 20480
    s_mov_b32 m0, 136192
    s_nop 0
    buffer_load_dwordx4 v1, s[56:59], s4 offen nt lds
    s_add_u32 s4, s4, 20480
    s_mov_b32 m0, 137216
    s_nop 0
    buffer_load_dwordx4 v1, s[56:59], s4 offen nt lds
    s_add_u32 s4, s4, 20480
    s_mov_b32 m0, 138240
    s_nop 0
    buffer_load_dwordx4 v1, s[56:59], s4 offen nt lds
    s_add_u32 s4, s4, 20480
    s_mov_b32 m0, 139264
    s_nop 0
    buffer_load_dwordx4 v1, s[56:59], s4 offen nt lds
    s_add_u32 s4, s4, 20480
    s_mov_b32 m0, 140288
    s_nop 0
    buffer_load_dwordx4 v1, s[56:59], s4 offen nt lds
    s_add_u32 s4, s4, 20480
    s_mov_b32 m0, 141312
    s_nop 0
    buffer_load_dwordx4 v1, s[56:59], s4 offen nt lds
    s_add_u32 s4, s4, 20480
    s_mov_b32 m0, 142336
    s_nop 0
    buffer_load_dwordx4 v1, s[56:59], s4 offen nt lds
    s_add_u32 s4, s4, 20480
    s_mov_b32 m0, 143360
    s_nop 0
    buffer_load_dwordx4 v1, s[56:59], s4 offen nt lds
    s_add_u32 s4, s4, 20480
    s_mov_b32 m0, 144384
    s_nop 0
    buffer_load_dwordx4 v1, s[56:59], s4 offen nt lds
    s_add_u32 s4, s4, 20480
    s_mov_b32 m0, 145408
    s_nop 0
    buffer_load_dwordx4 v1, s[56:59], s4 offen nt lds
    s_add_u32 s4, s4, 20480
    s_mov_b32 m0, 146432
    s_nop 0
    buffer_load_dwordx4 v1, s[56:59], s4 offen nt lds
    s_add_u32 s4, s4, 20480
    s_mov_b32 m0, 147456
    s_nop 0
    buffer_load_dwordx4 v1, s[56:59], s4 offen nt lds
    s_add_u32 s4, s4, 20480
    s_mov_b32 m0, 148480
    s_nop 0
    buffer_load_dwordx4 v1, s[56:59], s4 offen nt lds
    s_add_u32 s4, s4, 20480
    s_mov_b32 m0, 149504
    s_nop 0
    buffer_load_dwordx4 v1, s[56:59], s4 offen nt lds
    s_add_u32 s4, s4, 20480
    s_mov_b32 m0, 150528
    s_nop 0
    buffer_load_dwordx4 v1, s[56:59], s4 offen nt lds
    s_add_u32 s4, s4, 20480
    s_mov_b32 m0, 151552
    s_nop 0
    buffer_load_dwordx4 v1, s[56:59], s4 offen nt lds
    s_add_u32 s4, s4, 20480
    s_mov_b32 m0, 152576
    s_nop 0
    buffer_load_dwordx4 v1, s[56:59], s4 offen nt lds
    s_add_u32 s4, s4, 20480
    s_mov_b32 m0, 153600
    s_nop 0
    buffer_load_dwordx4 v1, s[56:59], s4 offen nt lds
    s_add_u32 s4, s4, 20480
    s_mov_b32 m0, 154624
    s_nop 0
    buffer_load_dwordx4 v1, s[56:59], s4 offen nt lds
    s_add_u32 s4, s4, 20480
    s_mov_b32 m0, 155648
    s_nop 0
    buffer_load_dwordx4 v1, s[56:59], s4 offen nt lds
    s_branch L_stE_249
L_stC_248:
    s_bitcmp1_b32 s15, 1
    s_cbranch_scc0 L_stE_249
    s_bitcmp1_b32 s51, 0
    s_cselect_b64 s[56:57], s[30:31], s[28:29]
    s_mov_b32 s58, 1966080
    s_mov_b32 s59, 0x20000
    v_lshrrev_b32 v2, 3, v0
    v_mul_u32_u24 v1, 3072, v2
    v_and_b32 v2, 2, v2
    v_and_b32 v3, 7, v0
    v_xor_b32 v2, v2, v3
    v_xor_b32 v3, 4, v2
    v_lshl_add_u32 v3, v3, 4, v1
    v_lshl_add_u32 v1, v2, 4, v1
    s_lshr_b32 s5, s51, 1
    s_lshl_b32 s5, s5, 7
    s_add_u32 s5, s5, 1376256
    s_mov_b32 m0, 115712
    s_nop 0
    buffer_load_dwordx4 v1, s[56:59], s5 offen nt lds
    s_add_u32 s5, s5, 24576
    s_mov_b32 m0, 116736
    s_nop 0
    buffer_load_dwordx4 v3, s[56:59], s5 offen nt lds
    s_add_u32 s5, s5, 24576
    s_mov_b32 m0, 117760
    s_nop 0
    buffer_load_dwordx4 v1, s[56:59], s5 offen nt lds
    s_add_u32 s5, s5, 24576
    s_mov_b32 m0, 118784
    s_nop 0
    buffer_load_dwordx4 v3, s[56:59], s5 offen nt lds
    s_add_u32 s5, s5, 24576
    s_mov_b32 m0, 119808
    s_nop 0
    buffer_load_dwordx4 v1, s[56:59], s5 offen nt lds
    s_add_u32 s5, s5, 24576
    s_mov_b32 m0, 120832
    s_nop 0
    buffer_load_dwordx4 v3, s[56:59], s5 offen nt lds
    s_add_u32 s5, s5, 24576
    s_mov_b32 m0, 121856
    s_nop 0
    buffer_load_dwordx4 v1, s[56:59], s5 offen nt lds
    s_add_u32 s5, s5, 24576
    s_mov_b32 m0, 122880
    s_nop 0
    buffer_load_dwordx4 v3, s[56:59], s5 offen nt lds
    s_add_u32 s5, s5, 24576
    s_mov_b32 m0, 123904
    s_nop 0
    buffer_load_dwordx4 v1, s[56:59], s5 offen nt lds
    s_add_u32 s5, s5, 24576
    s_mov_b32 m0, 124928
    s_nop 0
    buffer_load_dwordx4 v3, s[56:59], s5 offen nt lds
    s_add_u32 s5, s5, 24576
    s_mov_b32 m0, 125952
    s_nop 0
    buffer_load_dwordx4 v1, s[56:59], s5 offen nt lds
    s_add_u32 s5, s5, 24576
    s_mov_b32 m0, 126976
    s_nop 0
    buffer_load_dwordx4 v3, s[56:59], s5 offen nt lds
    s_add_u32 s5, s5, 24576
    s_mov_b32 m0, 128000
    s_nop 0
    buffer_load_dwordx4 v1, s[56:59], s5 offen nt lds
    s_add_u32 s5, s5, 24576
    s_mov_b32 m0, 129024
    s_nop 0
    buffer_load_dwordx4 v3, s[56:59], s5 offen nt lds
    s_add_u32 s5, s5, 24576
    s_mov_b32 m0, 130048
    s_nop 0
    buffer_load_dwordx4 v1, s[56:59], s5 offen nt lds
    s_add_u32 s5, s5, 24576
    s_mov_b32 m0, 131072
    s_nop 0
    buffer_load_dwordx4 v3, s[56:59], s5 offen nt lds
    s_add_u32 s5, s5, 24576
    s_mov_b32 m0, 132096
    s_nop 0
    buffer_load_dwordx4 v1, s[56:59], s5 offen nt lds
    s_add_u32 s5, s5, 24576
    s_mov_b32 m0, 133120
    s_nop 0
    buffer_load_dwordx4 v3, s[56:59], s5 offen nt lds
    s_add_u32 s5, s5, 24576
    s_mov_b32 m0, 134144
    s_nop 0
    buffer_load_dwordx4 v1, s[56:59], s5 offen nt lds
    s_add_u32 s5, s5, 24576
    s_mov_b32 m0, 135168
    s_nop 0
    buffer_load_dwordx4 v3, s[56:59], s5 offen nt lds
    s_add_u32 s5, s5, 24576
    s_mov_b32 m0, 136192
    s_nop 0
    buffer_load_dwordx4 v1, s[56:59], s5 offen nt lds
    s_add_u32 s5, s5, 24576
    s_mov_b32 m0, 137216
    s_nop 0
    buffer_load_dwordx4 v3, s[56:59], s5 offen nt lds
    s_add_u32 s5, s5, 24576
    s_mov_b32 m0, 138240
    s_nop 0
    buffer_load_dwordx4 v1, s[56:59], s5 offen nt lds
    s_add_u32 s5, s5, 24576
    s_mov_b32 m0, 139264
    s_nop 0
    buffer_load_dwordx4 v3, s[56:59], s5 offen nt lds
L_stE_249:
    v_mov_b32 v3, 1556
    s_mov_b32 s13, 4194304
L_lw_251:
    s_sleep 8
    ds_read_b32 v4, v3
    s_sub_u32 s13, s13, 1
    s_waitcnt lgkmcnt(0)
    v_readfirstlane_b32 s10, v4
    s_nop 0
    s_cselect_b32 s10, 1, s10
    s_cmp_eq_u32 s10, 1
    s_cbranch_scc0 L_lw_251
    v_lshlrev_b32 v2, 4, v0
    s_branch L_Qg
L_s3b:
    s_bitcmp1_b32 s15, 0
    s_cbranch_scc1 L_R0
    s_bitcmp1_b32 s15, 1
    s_cbranch_scc0 L_s23
    v_mov_b32 v1, 0
    v_mov_b32 v2, 0
    v_mov_b32 v3, 0
    v_mov_b32 v4, 0
    v_mov_b32 v5, 0
    v_mov_b32 v6, 0
    v_mov_b32 v7, 0
    s_mov_b64 exec, 0
    s_branch L_LN
L_wLN:
    s_mov_b64 exec, -1
L_LN0:
    v_mov_b32 v1, 0
    s_mov_b32 s13, 4194304
L_prog_252:
    s_sleep 32
    ds_read_b32 v2, v1 offset:1544
    s_sub_u32 s13, s13, 1
    s_waitcnt lgkmcnt(0)
    v_readfirstlane_b32 s4, v2
    s_nop 0
    s_cselect_b32 s4, 999, s4
    s_cmp_lt_u32 s4, 72
    s_cbranch_scc1 L_prog_252
    v_lshlrev_b32 v1, 4, v0
    s_and_b32 s8, s3, 1
    s_mul_i32 s11, s8, 0x02020000
    s_add_u32 s11, s11, 0x01000c0c
    s_mov_b32 s4, 19456
    s_mov_b32 s5, 23552
    s_mov_b32 s6, 24576
    s_mov_b32 s7, 28672
    s_mov_b32 s13, 4194304
L_poll_253:
    buffer_load_dwordx4 v[8:11], v1, s[52:55], s6 offen offset:0 sc1
    buffer_load_dwordx4 v[12:15], v1, s[52:55], s6 offen offset:1024 sc1
    buffer_load_dwordx4 v[16:19], v1, s[52:55], s6 offen offset:2048 sc1
    buffer_load_dwordx4 v[20:23], v1, s[52:55], s6 offen offset:3072 sc1
    buffer_load_dwordx4 v[24:27], v1, s[52:55], s7 offen offset:0 sc1
    buffer_load_dwordx4 v[28:31], v1, s[52:55], s4 offen offset:0 sc1
    buffer_load_dwordx4 v[32:35], v1, s[52:55], s4 offen offset:1024 sc1
    buffer_load_dwordx4 v[36:39], v1, s[52:55], s4 offen offset:2048 sc1
    buffer_load_dwordx4 v[40:43], v1, s[52:55], s4 offen offset:3072 sc1
    buffer_load_dwordx4 v[44:47], v1, s[52:55], s5 offen offset:0 sc1
    s_waitcnt vmcnt(9)
    v_xor_b32 v4, s44, v9
    v_bitop3_b32 v4, v11, s44, v4 bitop3:0xbe
    s_waitcnt vmcnt(8)
    v_bitop3_b32 v4, v13, s44, v4 bitop3:0xbe
    v_bitop3_b32 v4, v15, s44, v4 bitop3:0xbe
    s_waitcnt vmcnt(7)
    v_bitop3_b32 v4, v17, s44, v4 bitop3:0xbe
    v_bitop3_b32 v4, v19, s44, v4 bitop3:0xbe
    s_waitcnt vmcnt(6)
    v_bitop3_b32 v4, v21, s44, v4 bitop3:0xbe
    v_bitop3_b32 v4, v23, s44, v4 bitop3:0xbe
    s_waitcnt vmcnt(5)
    v_bitop3_b32 v4, v25, s44, v4 bitop3:0xbe
    v_bitop3_b32 v4, v27, s44, v4 bitop3:0xbe
    s_waitcnt vmcnt(4)
    v_bitop3_b32 v4, v29, s44, v4 bitop3:0xbe
    v_bitop3_b32 v4, v31, s44, v4 bitop3:0xbe
    s_waitcnt vmcnt(3)
    v_bitop3_b32 v4, v33, s44, v4 bitop3:0xbe
    v_bitop3_b32 v4, v35, s44, v4 bitop3:0xbe
    s_waitcnt vmcnt(2)
    v_bitop3_b32 v4, v37, s44, v4 bitop3:0xbe
    v_bitop3_b32 v4, v39, s44, v4 bitop3:0xbe
    s_waitcnt vmcnt(1)
    v_bitop3_b32 v4, v41, s44, v4 bitop3:0xbe
    v_bitop3_b32 v4, v43, s44, v4 bitop3:0xbe
    s_waitcnt vmcnt(0)
    v_bitop3_b32 v4, v45, s44, v4 bitop3:0xbe
    v_bitop3_b32 v4, v47, s44, v4 bitop3:0xbe
    v_cmp_ne_u32 vcc, 0, v4
    s_nop 0
    s_cbranch_vccz L_ok_254
    s_sleep 32
    s_sub_u32 s13, s13, 1
    s_cbranch_scc0 L_poll_253
L_ok_254:
    v_perm_b32 v8, v8, v8, s11
    v_perm_b32 v9, v10, v10, s11
    v_perm_b32 v12, v12, v12, s11
    v_perm_b32 v13, v14, v14, s11
    v_perm_b32 v16, v16, v16, s11
    v_perm_b32 v17, v18, v18, s11
    v_perm_b32 v20, v20, v20, s11
    v_perm_b32 v21, v22, v22, s11
    v_perm_b32 v24, v24, v24, s11
    v_perm_b32 v25, v26, v26, s11
    v_perm_b32 v28, v28, v28, s11
    v_perm_b32 v29, v30, v30, s11
    v_perm_b32 v32, v32, v32, s11
    v_perm_b32 v33, v34, v34, s11
    v_perm_b32 v36, v36, v36, s11
    v_perm_b32 v37, v38, v38, s11
    v_perm_b32 v40, v40, v40, s11
    v_perm_b32 v41, v42, v42, s11
    v_perm_b32 v44, v44, v44, s11
    v_perm_b32 v45, v46, v46, s11
    v_add_f32 v8, 1.0, v8
    v_cvt_pk_bf16_f32 v8, v8, v8
    v_and_b32 v8, 0xffff0000, v8
    v_add_f32 v9, 1.0, v9
    v_cvt_pk_bf16_f32 v9, v9, v9
    v_and_b32 v9, 0xffff0000, v9
    v_add_f32 v12, 1.0, v12
    v_cvt_pk_bf16_f32 v12, v12, v12
    v_and_b32 v12, 0xffff0000, v12
    v_add_f32 v13, 1.0, v13
    v_cvt_pk_bf16_f32 v13, v13, v13
    v_and_b32 v13, 0xffff0000, v13
    v_add_f32 v16, 1.0, v16
    v_cvt_pk_bf16_f32 v16, v16, v16
    v_and_b32 v16, 0xffff0000, v16
    v_add_f32 v17, 1.0, v17
    v_cvt_pk_bf16_f32 v17, v17, v17
    v_and_b32 v17, 0xffff0000, v17
    v_add_f32 v20, 1.0, v20
    v_cvt_pk_bf16_f32 v20, v20, v20
    v_and_b32 v20, 0xffff0000, v20
    v_add_f32 v21, 1.0, v21
    v_cvt_pk_bf16_f32 v21, v21, v21
    v_and_b32 v21, 0xffff0000, v21
    v_add_f32 v24, 1.0, v24
    v_cvt_pk_bf16_f32 v24, v24, v24
    v_and_b32 v24, 0xffff0000, v24
    v_add_f32 v25, 1.0, v25
    v_cvt_pk_bf16_f32 v25, v25, v25
    v_and_b32 v25, 0xffff0000, v25
    s_lshl_b32 s4, s48, 13
    s_add_u32 s4, s4, 65536
    s_add_u32 s5, s4, 4096
    s_mul_i32 s8, s8, 1344
    s_add_u32 s8, s8, 6144
    v_lshl_add_u32 v2, v0, 2, s8
    s_mov_b32 s10, 0x3acccccd
    v_mov_b32 v68, 0x3727c5ac
    s_barrier
    s_barrier
    s_barrier
L_LN:
    s_mov_b32 s13, 4194304
L_poll_256:
    s_cbranch_execz L_lv_259
    buffer_load_dwordx4 v[48:51], v1, s[52:55], s4 offen offset:0 sc1
    buffer_load_dwordx4 v[52:55], v1, s[52:55], s4 offen offset:1024 sc1
    buffer_load_dwordx4 v[56:59], v1, s[52:55], s4 offen offset:2048 sc1
    buffer_load_dwordx4 v[60:63], v1, s[52:55], s4 offen offset:3072 sc1
    buffer_load_dwordx4 v[64:67], v1, s[52:55], s5 offen offset:0 sc1
L_lv_259:
    s_waitcnt vmcnt(4)
    v_xor_b32 v70, s44, v49
    v_bitop3_b32 v70, v51, s44, v70 bitop3:0xbe
    v_perm_b32 v48, v48, v48, s11
    v_perm_b32 v49, v50, v50, s11
    v_readlane_b32 s8, v48, 0
    s_nop 1
    v_pk_add_f32 v[48:49], v[48:49], s[8:9] op_sel_hi:[1,0] neg_lo:[0,1] neg_hi:[0,1]
    v_pk_mul_f32 v[6:7], v[48:49], v[48:49]
    s_waitcnt vmcnt(3)
    v_bitop3_b32 v70, v53, s44, v70 bitop3:0xbe
    v_bitop3_b32 v70, v55, s44, v70 bitop3:0xbe
    v_perm_b32 v52, v52, v52, s11
    v_perm_b32 v53, v54, v54, s11
    v_pk_add_f32 v[52:53], v[52:53], s[8:9] op_sel_hi:[1,0] neg_lo:[0,1] neg_hi:[0,1]
    v_pk_add_f32 v[4:5], v[48:49], v[52:53]
    v_pk_fma_f32 v[6:7], v[52:53], v[52:53], v[6:7]
    s_waitcnt vmcnt(2)
    v_bitop3_b32 v70, v57, s44, v70 bitop3:0xbe
    v_bitop3_b32 v70, v59, s44, v70 bitop3:0xbe
    v_perm_b32 v56, v56, v56, s11
    v_perm_b32 v57, v58, v58, s11
    v_pk_add_f32 v[56:57], v[56:57], s[8:9] op_sel_hi:[1,0] neg_lo:[0,1] neg_hi:[0,1]
    v_pk_add_f32 v[4:5], v[4:5], v[56:57]
    v_pk_fma_f32 v[6:7], v[56:57], v[56:57], v[6:7]
    s_waitcnt vmcnt(1)
    v_bitop3_b32 v70, v61, s44, v70 bitop3:0xbe
    v_bitop3_b32 v70, v63, s44, v70 bitop3:0xbe
    v_perm_b32 v60, v60, v60, s11
    v_perm_b32 v61, v62, v62, s11
    v_pk_add_f32 v[60:61], v[60:61], s[8:9] op_sel_hi:[1,0] neg_lo:[0,1] neg_hi:[0,1]
    v_pk_add_f32 v[4:5], v[4:5], v[60:61]
    v_pk_fma_f32 v[6:7], v[60:61], v[60:61], v[6:7]
    s_waitcnt vmcnt(0)
    v_bitop3_b32 v70, v65, s44, v70 bitop3:0xbe
    v_bitop3_b32 v70, v67, s44, v70 bitop3:0xbe
    v_perm_b32 v64, v64, v64, s11
    v_perm_b32 v65, v66, v66, s11
    v_pk_add_f32 v[64:65], v[64:65], s[8:9] op_sel_hi:[1,0] neg_lo:[0,1] neg_hi:[0,1]
    v_pk_add_f32 v[4:5], v[4:5], v[64:65]
    v_pk_fma_f32 v[6:7], v[64:65], v[64:65], v[6:7]
    v_cmp_ne_u32 vcc, 0, v70
    s_nop 0
    s_cbranch_vccz L_ok_257
    s_sub_u32 s13, s13, 1
    s_cbranch_scc0 L_poll_256
L_ok_257:
    v_add_f32 v4, v4, v5
    v_add_f32 v6, v6, v7
    v_pk_mul_f32 v[48:49], v[48:49], v[8:9]
    s_nop 0
    v_permlane32_swap_b32 v4, v6
    v_add_f32 v4, v4, v6
    v_pk_mul_f32 v[52:53], v[52:53], v[12:13]
    v_pk_mul_f32 v[56:57], v[56:57], v[16:17]
    v_add_f32_dpp v4, v4, v4 quad_perm:[1,0,3,2] row_mask:0xf bank_mask:0xf
    v_pk_mul_f32 v[60:61], v[60:61], v[20:21]
    v_pk_mul_f32 v[64:65], v[64:65], v[24:25]
    v_add_f32_dpp v4, v4, v4 quad_perm:[2,3,0,1] row_mask:0xf bank_mask:0xf
    s_nop 1
    v_add_f32_dpp v4, v4, v4 row_half_mirror row_mask:0xf bank_mask:0xf
    s_nop 1
    v_add_f32_dpp v4, v4, v4 row_mirror row_mask:0xf bank_mask:0xf
    v_mov_b32 v5, v4
    s_nop 1
    v_permlane16_swap_b32 v4, v5
    v_add_f32 v4, v4, v5
    v_mul_f32 v4, s10, v4
    v_mov_b32 v6, v4
    s_nop 1
    v_permlane32_swap_b32 v4, v6
    v_fma_f32 v6, -v4, v4, v6
    v_max_f32 v6, 0, v6
    v_add_f32 v6, v6, v68
    v_rsq_f32 v6, v6
    v_pk_fma_f32 v[48:49], v[8:9], v[4:5], v[48:49] op_sel_hi:[1,0,1] neg_lo:[0,1,0] neg_hi:[0,1,0]
    v_pk_fma_f32 v[52:53], v[12:13], v[4:5], v[52:53] op_sel_hi:[1,0,1] neg_lo:[0,1,0] neg_hi:[0,1,0]
    v_pk_fma_f32 v[56:57], v[16:17], v[4:5], v[56:57] op_sel_hi:[1,0,1] neg_lo:[0,1,0] neg_hi:[0,1,0]
    v_pk_fma_f32 v[60:61], v[20:21], v[4:5], v[60:61] op_sel_hi:[1,0,1] neg_lo:[0,1,0] neg_hi:[0,1,0]
    v_pk_fma_f32 v[64:65], v[24:25], v[4:5], v[64:65] op_sel_hi:[1,0,1] neg_lo:[0,1,0] neg_hi:[0,1,0]
    v_pk_fma_f32 v[48:49], v[48:49], v[6:7], v[28:29] op_sel_hi:[1,0,1]
    v_cvt_pk_bf16_f32 v48, v48, v49
    v_pk_fma_f32 v[52:53], v[52:53], v[6:7], v[32:33] op_sel_hi:[1,0,1]
    v_cvt_pk_bf16_f32 v52, v52, v53
    ds_write2st64_b32 v2, v48, v52 offset0:0 offset1:1
    v_pk_fma_f32 v[56:57], v[56:57], v[6:7], v[36:37] op_sel_hi:[1,0,1]
    v_cvt_pk_bf16_f32 v56, v56, v57
    v_pk_fma_f32 v[60:61], v[60:61], v[6:7], v[40:41] op_sel_hi:[1,0,1]
    v_cvt_pk_bf16_f32 v60, v60, v61
    ds_write2st64_b32 v2, v56, v60 offset0:2 offset1:3
    v_pk_fma_f32 v[64:65], v[64:65], v[6:7], v[44:45] op_sel_hi:[1,0,1]
    v_cvt_pk_bf16_f32 v64, v64, v65
    ds_write_b32 v2, v64 offset:1024
    s_cbranch_execz L_wLN
    s_waitcnt lgkmcnt(0)
    s_barrier
    s_endpgm
L_s23:
    s_bitcmp1_b32 s15, 3
    s_cbranch_scc0 L_exit
    v_mov_b32 v1, 0
    s_mov_b32 s13, 4194304
L_prog_260:
    s_sleep 32
    ds_read_b32 v2, v1 offset:1544
    s_sub_u32 s13, s13, 1
    s_waitcnt lgkmcnt(0)
    v_readfirstlane_b32 s4, v2
    s_nop 0
    s_cselect_b32 s4, 999, s4
    s_cmp_lt_u32 s4, 72
    s_cbranch_scc1 L_prog_260
    v_and_b32 v6, 31, v0
    v_lshlrev_b32 v6, 3, v6
    s_lshl_b32 s9, s14, 8
    s_add_u32 s9, s9, 29696
    s_mov_b32 s13, 4194304
L_poll_261:
    buffer_load_dwordx2 v[10:11], v6, s[52:55], s9 offen sc1
    s_waitcnt vmcnt(0)
    v_xor_b32 v12, s44, v11
    v_cmp_ne_u32 vcc, 0, v12
    s_nop 0
    s_cbranch_vccz L_ok_262
    s_sleep 32
    s_sub_u32 s13, s13, 1
    s_cbranch_scc0 L_poll_261
L_ok_262:
L_D0:
    s_barrier
    s_branch L_D
    s_endpgm
L_C:
    s_cmp_lt_u32 s12, 4
    s_cbranch_scc0 L_exit
    s_bitcmp1_b32 s51, 0
    s_cselect_b64 s[56:57], s[30:31], s[28:29]
    s_mov_b32 s58, 1966080
    s_mov_b32 s59, 0x20000
    v_lshrrev_b32 v2, 3, v0
    v_mul_u32_u24 v1, 3072, v2
    v_and_b32 v2, 2, v2
    v_and_b32 v3, 7, v0
    v_xor_b32 v2, v2, v3
    v_xor_b32 v3, 4, v2
    v_lshl_add_u32 v3, v3, 4, v1
    v_lshl_add_u32 v1, v2, 4, v1
    s_lshr_b32 s5, s51, 1
    s_lshl_b32 s5, s5, 7
    s_mul_i32 s4, s12, 14
    s_mul_i32 s6, s4, 24576
    s_add_u32 s5, s5, s6
    s_lshl_b32 s4, s4, 10
    s_add_u32 s4, s4, 58368
    s_cbranch_execz L_lv_264
    s_barrier
    s_add_u32 m0, s4, 0
    s_nop 0
    buffer_load_dwordx4 v1, s[56:59], s5 offen nt lds
    s_add_u32 s5, s5, 24576
    s_add_u32 m0, s4, 1024
    s_nop 0
    buffer_load_dwordx4 v3, s[56:59], s5 offen nt lds
    s_add_u32 s5, s5, 24576
    s_add_u32 m0, s4, 2048
    s_nop 0
    buffer_load_dwordx4 v1, s[56:59], s5 offen nt lds
    s_add_u32 s5, s5, 24576
    s_add_u32 m0, s4, 3072
    s_nop 0
    buffer_load_dwordx4 v3, s[56:59], s5 offen nt lds
    s_add_u32 s5, s5, 24576
    s_add_u32 m0, s4, 4096
    s_nop 0
    buffer_load_dwordx4 v1, s[56:59], s5 offen nt lds
    s_add_u32 s5, s5, 24576
    s_add_u32 m0, s4, 5120
    s_nop 0
    buffer_load_dwordx4 v3, s[56:59], s5 offen nt lds
    s_add_u32 s5, s5, 24576
    s_add_u32 m0, s4, 6144
    s_nop 0
    buffer_load_dwordx4 v1, s[56:59], s5 offen nt lds
    s_add_u32 s5, s5, 24576
    s_add_u32 m0, s4, 7168
    s_nop 0
    buffer_load_dwordx4 v3, s[56:59], s5 offen nt lds
    s_add_u32 s5, s5, 24576
    s_add_u32 m0, s4, 8192
    s_nop 0
    buffer_load_dwordx4 v1, s[56:59], s5 offen nt lds
    s_add_u32 s5, s5, 24576
    s_add_u32 m0, s4, 9216
    s_nop 0
    buffer_load_dwordx4 v3, s[56:59], s5 offen nt lds
    s_add_u32 s5, s5, 24576
    s_add_u32 m0, s4, 10240
    s_nop 0
    buffer_load_dwordx4 v1, s[56:59], s5 offen nt lds
    s_add_u32 s5, s5, 24576
    s_add_u32 m0, s4, 11264
    s_nop 0
    buffer_load_dwordx4 v3, s[56:59], s5 offen nt lds
    s_add_u32 s5, s5, 24576
    s_add_u32 m0, s4, 12288
    s_nop 0
    buffer_load_dwordx4 v1, s[56:59], s5 offen nt lds
    s_add_u32 s5, s5, 24576
    s_add_u32 m0, s4, 13312
    s_nop 0
    buffer_load_dwordx4 v3, s[56:59], s5 offen nt lds
L_lv_264:
    v_lshrrev_b32 v2, 4, v0
    v_mul_u32_u24 v2, 1024, v2
    v_bfe_u32 v3, v0, 2, 2
    v_mul_u32_u24 v3, 128, v3
    v_add_u32 v2, v2, v3
    v_and_b32 v3, 3, v0
    v_lshl_add_u32 v2, v3, 3, v2
    v_bfe_u32 v3, v0, 3, 2
    v_xor_b32 v3, s12, v3
    v_lshl_add_u32 v2, v3, 5, v2
    v_add_u32 v2, 58368, v2
    v_add_u32 v5, 40960, v2
    v_and_b32 v3, 1, v0
    v_mul_u32_u24 v3, 1344, v3
    v_lshrrev_b32 v4, 4, v0
    v_mul_u32_u24 v4, 16, v4
    v_add_u32 v3, v3, v4
    v_add_u32 v3, 6144, v3
    s_and_b32 s4, s51, 1
    s_mul_i32 s6, s4, 12288
    s_lshr_b32 s5, s51, 1
    s_lshl2_add_u32 s5, s5, s12
    s_lshl_b32 s5, s5, 7
    s_add_u32 s6, s6, s5
    s_add_u32 s6, s6, 40960
    v_lshlrev_b32 v1, 3, v0
    s_mov_b32 s7, 0xbfb8aa3b
    v_mov_b32 v77, s44
    s_add_u32 s8, s6, 122880
    s_waitcnt vmcnt(0)
    s_cbranch_execz L_lv_265
    s_barrier
L_lv_265:
    ds_read_b64_tr_b16 v[88:89], v2 offset:0
    ds_read_b64_tr_b16 v[90:91], v2 offset:512
    ds_read_b64_tr_b16 v[92:93], v2 offset:4096
    ds_read_b64_tr_b16 v[94:95], v2 offset:4608
    ds_read_b64_tr_b16 v[96:97], v2 offset:8192
    ds_read_b64_tr_b16 v[98:99], v2 offset:8704
    ds_read_b64_tr_b16 v[100:101], v2 offset:12288
    ds_read_b64_tr_b16 v[102:103], v2 offset:12800
    ds_read_b64_tr_b16 v[104:105], v2 offset:16384
    ds_read_b64_tr_b16 v[106:107], v2 offset:16896
    ds_read_b64_tr_b16 v[108:109], v2 offset:20480
    ds_read_b64_tr_b16 v[110:111], v2 offset:20992
    ds_read_b64_tr_b16 v[112:113], v2 offset:24576
    ds_read_b64_tr_b16 v[114:115], v2 offset:25088
    ds_read_b64_tr_b16 v[116:117], v2 offset:28672
    ds_read_b64_tr_b16 v[118:119], v2 offset:29184
    ds_read_b64_tr_b16 v[120:121], v2 offset:32768
    ds_read_b64_tr_b16 v[122:123], v2 offset:33280
    ds_read_b64_tr_b16 v[124:125], v2 offset:36864
    ds_read_b64_tr_b16 v[126:127], v2 offset:37376
    ds_read_b64_tr_b16 v[128:129], v5 offset:0
    ds_read_b64_tr_b16 v[130:131], v5 offset:512
    ds_read_b64_tr_b16 v[132:133], v5 offset:4096
    ds_read_b64_tr_b16 v[134:135], v5 offset:4608
    ds_read_b64_tr_b16 v[136:137], v5 offset:8192
    ds_read_b64_tr_b16 v[138:139], v5 offset:8704
    ds_read_b64_tr_b16 v[140:141], v5 offset:12288
    ds_read_b64_tr_b16 v[142:143], v5 offset:12800
    ds_read_b64_tr_b16 v[144:145], v5 offset:16384
    ds_read_b64_tr_b16 v[146:147], v5 offset:16896
    ds_read_b64_tr_b16 v[148:149], v5 offset:20480
    ds_read_b64_tr_b16 v[150:151], v5 offset:20992
    ds_read_b64_tr_b16 v[152:153], v5 offset:24576
    ds_read_b64_tr_b16 v[154:155], v5 offset:25088
    ds_read_b64_tr_b16 v[156:157], v5 offset:28672
    ds_read_b64_tr_b16 v[158:159], v5 offset:29184
    ds_read_b64_tr_b16 v[160:161], v5 offset:32768
    ds_read_b64_tr_b16 v[162:163], v5 offset:33280
    ds_read_b64_tr_b16 v[164:165], v5 offset:36864
    ds_read_b64_tr_b16 v[166:167], v5 offset:37376
    s_waitcnt lgkmcnt(0)
    s_cbranch_execz L_lv_266
    s_barrier
L_lv_266:
    ds_read_b128 v[8:11], v3 offset:0
    ds_read_b128 v[12:15], v3 offset:64
    ds_read_b128 v[16:19], v3 offset:128
    ds_read_b128 v[20:23], v3 offset:192
    ds_read_b128 v[24:27], v3 offset:256
    ds_read_b128 v[28:31], v3 offset:320
    ds_read_b128 v[32:35], v3 offset:384
    ds_read_b128 v[36:39], v3 offset:448
    ds_read_b128 v[40:43], v3 offset:512
    ds_read_b128 v[44:47], v3 offset:576
    ds_read_b128 v[48:51], v3 offset:640
    ds_read_b128 v[52:55], v3 offset:704
    ds_read_b128 v[56:59], v3 offset:768
    ds_read_b128 v[60:63], v3 offset:832
    ds_read_b128 v[64:67], v3 offset:896
    s_waitcnt lgkmcnt(14)
    v_mfma_f32_16x16x32_bf16 v[72:75], v[8:11], v[88:91], 0
    ds_read_b128 v[8:11], v3 offset:960
    s_waitcnt lgkmcnt(14)
    v_mfma_f32_16x16x32_bf16 v[72:75], v[12:15], v[92:95], v[72:75]
    ds_read_b128 v[12:15], v3 offset:1024
    s_waitcnt lgkmcnt(14)
    v_mfma_f32_16x16x32_bf16 v[72:75], v[16:19], v[96:99], v[72:75]
    ds_read_b128 v[16:19], v3 offset:1088
    s_waitcnt lgkmcnt(14)
    v_mfma_f32_16x16x32_bf16 v[72:75], v[20:23], v[100:103], v[72:75]
    ds_read_b128 v[20:23], v3 offset:1152
    s_waitcnt lgkmcnt(14)
    v_mfma_f32_16x16x32_bf16 v[72:75], v[24:27], v[104:107], v[72:75]
    ds_read_b128 v[24:27], v3 offset:1216
    s_waitcnt lgkmcnt(14)
    v_mfma_f32_16x16x32_bf16 v[72:75], v[28:31], v[108:111], v[72:75]
    s_waitcnt lgkmcnt(13)
    v_mfma_f32_16x16x32_bf16 v[72:75], v[32:35], v[112:115], v[72:75]
    s_waitcnt lgkmcnt(12)
    v_mfma_f32_16x16x32_bf16 v[72:75], v[36:39], v[116:119], v[72:75]
    s_waitcnt lgkmcnt(11)
    v_mfma_f32_16x16x32_bf16 v[72:75], v[40:43], v[120:123], v[72:75]
    s_waitcnt lgkmcnt(10)
    v_mfma_f32_16x16x32_bf16 v[72:75], v[44:47], v[124:127], v[72:75]
    s_waitcnt lgkmcnt(9)
    v_mfma_f32_16x16x32_bf16 v[72:75], v[48:51], v[128:131], v[72:75]
    s_waitcnt lgkmcnt(8)
    v_mfma_f32_16x16x32_bf16 v[72:75], v[52:55], v[132:135], v[72:75]
    s_waitcnt lgkmcnt(7)
    v_mfma_f32_16x16x32_bf16 v[72:75], v[56:59], v[136:139], v[72:75]
    s_waitcnt lgkmcnt(6)
    v_mfma_f32_16x16x32_bf16 v[72:75], v[60:63], v[140:143], v[72:75]
    s_waitcnt lgkmcnt(5)
    v_mfma_f32_16x16x32_bf16 v[72:75], v[64:67], v[144:147], v[72:75]
    s_waitcnt lgkmcnt(4)
    v_mfma_f32_16x16x32_bf16 v[72:75], v[8:11], v[148:151], v[72:75]
    s_waitcnt lgkmcnt(3)
    v_mfma_f32_16x16x32_bf16 v[72:75], v[12:15], v[152:155], v[72:75]
    s_waitcnt lgkmcnt(2)
    v_mfma_f32_16x16x32_bf16 v[72:75], v[16:19], v[156:159], v[72:75]
    s_waitcnt lgkmcnt(1)
    v_mfma_f32_16x16x32_bf16 v[72:75], v[20:23], v[160:163], v[72:75]
    s_waitcnt lgkmcnt(0)
    v_mfma_f32_16x16x32_bf16 v[72:75], v[24:27], v[164:167], v[72:75]
    s_cmp_eq_u32 s4, 1
    s_cbranch_scc1 L_up_267
    s_nop 5
    v_mul_f32 v74, s7, v72
    v_mul_f32 v75, s7, v73
    v_exp_f32 v74, v74
    v_exp_f32 v75, v75
    v_add_f32 v74, 1.0, v74
    v_add_f32 v75, 1.0, v75
    v_rcp_f32 v74, v74
    v_rcp_f32 v75, v75
    v_mul_f32 v72, v72, v74
    v_mul_f32 v73, v73, v75
L_up_267:
    s_nop 5
    v_cvt_pk_bf16_f32 v76, v72, v73
    s_cbranch_execz L_wC
    s_mov_b64 exec, 0xffff
    buffer_store_dwordx2 v[76:77], v1, s[52:55], s6 offen sc1
    buffer_store_dwordx2 v[76:77], v1, s[52:55], s8 offen
    s_endpgm
L_D:
    s_lshl_b32 s4, s12, 13
    s_add_u32 s4, s4, 58368
    s_mov_b32 s56, s32
    s_mov_b32 s57, s33
    s_mov_b32 s58, 1966080
    s_mov_b32 s59, 0x20000
    v_lshrrev_b32 v1, 2, v0
    v_mul_u32_u24 v1, 1280, v1
    v_and_b32 v2, 3, v0
    v_lshl_add_u32 v1, v2, 4, v1
    s_mul_i32 s5, s12, 163840
    s_lshl_b32 s6, s14, 6
    s_add_u32 s5, s5, s6
    s_mov_b32 s60, s38
    s_mov_b32 s61, s39
    s_mov_b32 s62, 2560
    s_mov_b32 s63, 0x20000
    s_cbranch_execz L_lv_269
    s_barrier
    s_cmp_ge_u32 s12, 9
    s_cbranch_scc1 L_have_268
    s_add_u32 m0, s4, 0
    s_nop 0
    buffer_load_dwordx4 v1, s[56:59], s5 offen nt lds
    s_add_u32 s5, s5, 20480
    s_add_u32 m0, s4, 1024
    s_nop 0
    buffer_load_dwordx4 v1, s[56:59], s5 offen nt lds
    s_add_u32 s5, s5, 20480
    s_add_u32 m0, s4, 2048
    s_nop 0
    buffer_load_dwordx4 v1, s[56:59], s5 offen nt lds
    s_add_u32 s5, s5, 20480
    s_add_u32 m0, s4, 3072
    s_nop 0
    buffer_load_dwordx4 v1, s[56:59], s5 offen nt lds
    s_add_u32 s5, s5, 20480
    s_add_u32 m0, s4, 4096
    s_nop 0
    buffer_load_dwordx4 v1, s[56:59], s5 offen nt lds
    s_add_u32 s5, s5, 20480
    s_add_u32 m0, s4, 5120
    s_nop 0
    buffer_load_dwordx4 v1, s[56:59], s5 offen nt lds
    s_add_u32 s5, s5, 20480
    s_add_u32 m0, s4, 6144
    s_nop 0
    buffer_load_dwordx4 v1, s[56:59], s5 offen nt lds
    s_add_u32 s5, s5, 20480
    s_add_u32 m0, s4, 7168
    s_nop 0
    buffer_load_dwordx4 v1, s[56:59], s5 offen nt lds
L_have_268:
L_lv_269:
    v_lshrrev_b32 v2, 4, v0
    v_mul_u32_u24 v2, 512, v2
    v_bfe_u32 v3, v0, 2, 2
    v_mul_u32_u24 v3, 64, v3
    v_add_u32 v2, v2, v3
    v_and_b32 v3, 3, v0
    v_lshl_add_u32 v2, v3, 3, v2
    v_add_u32 v2, s4, v2
    s_waitcnt vmcnt(0)
    ds_read_b64_tr_b16 v[40:41], v2 offset:0
    ds_read_b64_tr_b16 v[42:43], v2 offset:256
    ds_read_b64_tr_b16 v[44:45], v2 offset:2048
    ds_read_b64_tr_b16 v[46:47], v2 offset:2304
    ds_read_b64_tr_b16 v[48:49], v2 offset:4096
    ds_read_b64_tr_b16 v[50:51], v2 offset:4352
    ds_read_b64_tr_b16 v[52:53], v2 offset:6144
    ds_read_b64_tr_b16 v[54:55], v2 offset:6400
    ds_read_b64_tr_b16 v[56:57], v2 offset:32
    ds_read_b64_tr_b16 v[58:59], v2 offset:288
    ds_read_b64_tr_b16 v[60:61], v2 offset:2080
    ds_read_b64_tr_b16 v[62:63], v2 offset:2336
    ds_read_b64_tr_b16 v[64:65], v2 offset:4128
    ds_read_b64_tr_b16 v[66:67], v2 offset:4384
    ds_read_b64_tr_b16 v[68:69], v2 offset:6176
    ds_read_b64_tr_b16 v[70:71], v2 offset:6432
    s_lshl_b32 s4, s12, 9
    s_add_u32 s4, s4, 9216
    v_lshl_add_u32 v2, v0, 2, s4
    v_and_b32 v3, 1, v0
    v_mul_u32_u24 v3, 256, v3
    v_lshrrev_b32 v4, 4, v0
    v_mul_u32_u24 v4, 16, v4
    v_add_u32 v3, v3, v4
    v_add_u32 v3, s4, v3
    v_and_b32 v4, 31, v0
    v_mul_u32_u24 v4, 96, v4
    s_lshl_b32 s4, s12, 2
    s_add_u32 s4, s4, 15360
    v_add_u32 v4, s4, v4
    v_lshlrev_b32 v1, 4, v0
    s_lshl_b32 s5, s12, 10
    s_add_u32 s5, s5, 40960
    s_add_u32 s6, s5, 12288
    v_mov_b32 v5, 1536
    ds_read_b32 v6, v5
    s_lshl_b32 s7, s12, 1
    s_mul_i32 s8, s48, 3
    s_sub_u32 s7, s7, s8
    v_lshrrev_b32 v5, 5, v0
    v_add_u32 v5, s7, v5
    v_cmp_gt_u32 vcc, 3, v5
    s_waitcnt lgkmcnt(0)
    v_subrev_u32 v6, 1, v6
    s_nop 0
    v_readfirstlane_b32 s11, v6
    v_mul_u32_u24 v6, 122880, v6
    v_cndmask_b32 v5, 0, v6, vcc
    v_add_u32 v1, v1, v5
    v_and_b32 v5, 31, v0
    v_lshlrev_b32 v6, 3, v5
    v_lshrrev_b32 v7, 5, v0
    s_cmp_eq_u32 s12, 11
    s_cbranch_scc0 L_nofin_270
    s_lshl_b32 s8, s14, 8
    s_add_u32 s9, s8, 29696
    s_add_u32 s8, s8, 65536
    s_lshl_b32 s10, s48, 13
    s_add_u32 s8, s8, s10
    s_mov_b32 s13, 4194304
L_poll_271:
    s_cbranch_execz L_lv_274
    buffer_load_dwordx2 v[8:9], v6, s[52:55], s8 offen sc1
L_lv_274:
    s_waitcnt vmcnt(0)
    v_xor_b32 v12, s44, v9
    v_cmp_ne_u32 vcc, 0, v12
    s_nop 0
    s_cbranch_vccz L_ok_272
    s_sleep 8
    s_sub_u32 s13, s13, 1
    s_cbranch_scc0 L_poll_271
L_ok_272:
    v_lshlrev_b32 v9, 4, v7
    v_lshrrev_b32 v8, v9, v8
    v_lshlrev_b32 v8, 16, v8
    v_lshrrev_b32 v10, v9, v10
    v_lshlrev_b32 v10, 16, v10
L_nofin_270:
    v_lshl_add_u32 v6, v5, 1, v7
    v_mul_u32_u24 v6, 48, v6
    v_add_u32 v6, 15360, v6
    v_mul_u32_u24 v7, 1280, v7
    v_lshl_add_u32 v5, v5, 1, v7
    s_lshl_b32 s8, s14, 6
    s_cbranch_execz L_lv_275
    s_barrier
L_lv_275:
    s_mov_b32 s13, 4194304
L_poll_276:
    s_cbranch_execz L_lv_279
    buffer_load_dwordx4 v[16:19], v1, s[52:55], s5 offen sc1
    buffer_load_dwordx4 v[20:23], v1, s[52:55], s6 offen sc1
L_lv_279:
    s_waitcnt vmcnt(1)
    v_xor_b32 v12, s44, v17
    v_bitop3_b32 v12, v19, s44, v12 bitop3:0xbe
    v_and_b32 v17, 0xffff0000, v16
    v_lshlrev_b32 v16, 16, v16
    v_and_b32 v19, 0xffff0000, v18
    v_lshlrev_b32 v18, 16, v18
    s_waitcnt vmcnt(0)
    v_bitop3_b32 v12, v21, s44, v12 bitop3:0xbe
    v_bitop3_b32 v12, v23, s44, v12 bitop3:0xbe
    v_and_b32 v21, 0xffff0000, v20
    v_lshlrev_b32 v20, 16, v20
    v_and_b32 v23, 0xffff0000, v22
    v_lshlrev_b32 v22, 16, v22
    v_cmp_ne_u32 vcc, 0, v12
    s_nop 0
    s_cbranch_vccz L_ok_277
    s_sub_u32 s13, s13, 1
    s_cbranch_scc0 L_poll_276
L_ok_277:
    v_pk_mul_f32 v[16:17], v[16:17], v[20:21]
    v_pk_mul_f32 v[18:19], v[18:19], v[22:23]
    v_cvt_pk_bf16_f32 v16, v16, v18
    v_cvt_pk_bf16_f32 v17, v17, v19
    ds_write2st64_b32 v2, v16, v17 offset0:0 offset1:1
    s_waitcnt lgkmcnt(0)
    ds_read_b128 v[72:75], v3 offset:0
    ds_read_b128 v[76:79], v3 offset:64
    ds_read_b128 v[80:83], v3 offset:128
    ds_read_b128 v[84:87], v3 offset:192
    s_waitcnt lgkmcnt(3)
    v_mfma_f32_16x16x32_bf16 v[88:91], v[72:75], v[40:43], 0
    v_mfma_f32_16x16x32_bf16 v[92:95], v[72:75], v[56:59], 0
    s_waitcnt lgkmcnt(2)
    v_mfma_f32_16x16x32_bf16 v[88:91], v[76:79], v[44:47], v[88:91]
    v_mfma_f32_16x16x32_bf16 v[92:95], v[76:79], v[60:63], v[92:95]
    s_waitcnt lgkmcnt(1)
    v_mfma_f32_16x16x32_bf16 v[88:91], v[80:83], v[48:51], v[88:91]
    v_mfma_f32_16x16x32_bf16 v[92:95], v[80:83], v[64:67], v[92:95]
    s_waitcnt lgkmcnt(0)
    v_mfma_f32_16x16x32_bf16 v[88:91], v[84:87], v[52:55], v[88:91]
    v_mfma_f32_16x16x32_bf16 v[92:95], v[84:87], v[68:71], v[92:95]
    s_nop 7
    v_mov_b32_dpp v88, v92 quad_perm:[0,1,2,3] row_mask:0xa bank_mask:0xf
    v_mov_b32_dpp v89, v93 quad_perm:[0,1,2,3] row_mask:0xa bank_mask:0xf
    ds_write2_b32 v4, v88, v89 offset0:0 offset1:12
    s_waitcnt lgkmcnt(0)
    s_cbranch_execz L_lv_280
    s_barrier
L_lv_280:
    s_cmp_eq_u32 s12, 11
    s_cbranch_scc0 L_exit
    ds_read_b128 v[16:19], v6 offset:0
    ds_read_b128 v[20:23], v6 offset:16
    ds_read_b128 v[24:27], v6 offset:32
    s_waitcnt lgkmcnt(1)
    v_pk_add_f32 v[16:17], v[16:17], v[18:19]
    v_pk_add_f32 v[20:21], v[20:21], v[22:23]
    v_pk_add_f32 v[16:17], v[16:17], v[20:21]
    s_waitcnt lgkmcnt(0)
    v_pk_add_f32 v[24:25], v[24:25], v[26:27]
    v_pk_add_f32 v[16:17], v[16:17], v[24:25]
    v_add_f32 v16, v16, v17
    v_fma_f32 v16, v16, v10, v8
    s_nop 1
    v_mov_b32_dpp v17, v16 quad_perm:[1,1,3,3] row_mask:0xf bank_mask:0xf
    v_cvt_pk_bf16_f32 v16, v16, v17
    s_cbranch_execz L_wD
    s_mov_b32 exec_lo, 0x55555555
    s_mov_b32 exec_hi, 0x55555555
    buffer_store_dword v16, v5, s[60:63], s8 offen
    s_cmp_eq_u32 s14, 0
    s_cbranch_scc0 L_fin
    s_mov_b64 exec, 1
    v_mov_b32 v17, s44
    v_mov_b32 v18, 0
    buffer_store_dword v17, v18, s[52:55], 0 offen
L_fin:
L_exit:
L_end:
    s_endpgm
.section .rodata,"a"
.p2align 6
.amdhsa_kernel adaLN_cond__gqa_block_cached__swiglu_ffn__decode_kernel
  .amdhsa_next_free_vgpr 168
  .amdhsa_next_free_sgpr 96
  .amdhsa_accum_offset 168
  .amdhsa_group_segment_fixed_size 0
  .amdhsa_kernarg_size 112
  .amdhsa_user_sgpr_count 2
  .amdhsa_user_sgpr_kernarg_segment_ptr 1
  .amdhsa_system_sgpr_workgroup_id_x 1
  .amdhsa_float_denorm_mode_32 3
.end_amdhsa_kernel
```
